```python
import torch

def _softmax(x, axis=-1):
    return torch.softmax(x, dim=axis)
def _gelu(x):
    return torch.nn.functional.gelu(x, approximate="tanh")
def _silu(x):
    return torch.nn.functional.silu(x)
def _sigmoid(x):
    return torch.sigmoid(x)
def _layernorm(x, axis=-1, eps=1e-5):
    m = x.mean(dim=axis, keepdim=True)
    v = x.var(dim=axis, keepdim=True, unbiased=False)
    return (x - m) / torch.sqrt(v + eps)
def _scatter_add(tgt, idx, src, axis=0):
    return tgt.clone().index_add_(axis, idx, src)
def _segment_sum(src, seg, n):
    out = torch.zeros((n,) + src.shape[1:], dtype=src.dtype)
    return out.index_add_(0, seg, src)
def _pad(x, pw):
    flat = tuple(v for pair in reversed(pw) for v in pair)
    return torch.nn.functional.pad(x, flat)

kernel_name = 'gated_mix__linear_kernel_hedgehog__dense_activation_relu__prompt'

def setup_inputs():

    _w = (lambda a: (lambda t: t.to(torch.bfloat16) if t.is_floating_point() else t)(torch.as_tensor(a)))
    def _A_setup():
        B, S, D, H = 1, 2048, 512, 32
        Dh = D // H
        return {
            "x": _w((lambda *s: torch.randn(*s, dtype=torch.bfloat16) * 0.05)(B, S, D)),
            "wqkv": _w((lambda *s: torch.randn(*s, dtype=torch.bfloat16) * 1.6)(D, 3 * D)),
            "w_phi": _w((lambda *s: torch.randn(*s, dtype=torch.bfloat16) * 1.6)(H, Dh, Dh) * (Dh ** -0.5)),
            "wo": _w((lambda *s: torch.randn(*s, dtype=torch.bfloat16) * 0.1)(D, D)),
        }
    _A_in = _A_setup()

    def _B_setup():
        B, S, D, Dff = 1, 2048, 512, 1376
        return {
            "x": _w((lambda *s: torch.randn(*s, dtype=torch.bfloat16) * 0.05)(B, S, D)),
            "w1": _w((lambda *s: torch.randn(*s, dtype=torch.bfloat16) * 0.05)(D, Dff)),
            "w2": _w((lambda *s: torch.randn(*s, dtype=torch.bfloat16) * 0.05)(Dff, D)),
        }
    _B_in = _B_setup()

    return {
        "A_x": _A_in["x"],
        "A_wqkv": _A_in["wqkv"],
        "A_w_phi": _A_in["w_phi"],
        "A_wo": _A_in["wo"],
        "B_x": _B_in["x"],
        "B_w1": _B_in["w1"],
        "B_w2": _B_in["w2"],
        "gate_w": _w((lambda *s: torch.randn(*s, dtype=torch.bfloat16) * 0.05)(512) * 16.0),
    }

def reference(A_x, A_wqkv, A_w_phi, A_wo, B_x, B_w1, B_w2, gate_w):
    def _A_ref(x, wqkv, w_phi, wo):
        B, S, D = x.shape
        H = 32; Dh = D // H
        qkv = (lambda x, *d: x.permute(*d))((x @ wqkv).reshape(B, S, 3, H, Dh), 2, 0, 3, 1, 4)
        q, k, v = qkv[0], qkv[1], qkv[2]
        pq = torch.einsum("bhsd,hdf->bhsf", q, w_phi)
        pk = torch.einsum("bhsd,hdf->bhsf", k, w_phi)
        phi_q = torch.concatenate([_softmax(pq, axis=-1), _softmax(-pq, axis=-1)], axis=-1)
        phi_k = torch.concatenate([_softmax(pk, axis=-1), _softmax(-pk, axis=-1)], axis=-1)
        kv = torch.einsum("bhsf,bhsd->bhfd", phi_k, v)
        z  = torch.einsum("bhsf->bhf", phi_k)
        num = torch.einsum("bhqf,bhfd->bhqd", phi_q, kv)
        den = torch.einsum("bhqf,bhf->bhq", phi_q, z)[..., None] + 1e-6
        o = num / den
        return (lambda x, *d: x.permute(*d))(o, 0, 2, 1, 3).reshape(B, S, D) @ wo

    def _B_ref(x, w1, w2):
        h = torch.einsum("bsd,df->bsf", x, w1)
        zero = torch.zeros_like(h)
        h = torch.maximum(h, zero)
        return torch.einsum("bsf,fd->bsd", h, w2)

    x = A_x
    g = _sigmoid((x * gate_w).sum(-1, keepdims=True))
    a = _A_ref(x, A_wqkv, A_w_phi, A_wo)
    b = _B_ref(x, B_w1, B_w2)
    return g * a + (1 - g) * b
```

```asm
; @launch grid=(256,1,1) block=(512,1,1) lds=163840
.amdgcn_target "amdgcn-amd-amdhsa--gfx950"
.text
.globl gated_mix__linear_kernel_hedgehog__dense_activation_relu__prompt_kernel
.p2align 8
.type gated_mix__linear_kernel_hedgehog__dense_activation_relu__prompt_kernel,@function
gated_mix__linear_kernel_hedgehog__dense_activation_relu__prompt_kernel:
    s_cmp_ge_u32 s2, 256
    s_cbranch_scc1 L_end
    s_load_dwordx16 s[4:19], s[0:1], 0
    v_lshrrev_b32 v31, 6, v0
    s_and_b32 s68, s2, 7
    s_lshr_b32 s70, s2, 4
    v_readfirstlane_b32 s72, v31
    s_bfe_u32 s89, s2, 0x10003
    s_cmp_lt_u32 s70, 9
    s_cselect_b32 s71, 1, 0
    s_cselect_b32 s90, 0, 1
    v_bfe_u32 v24, v0, 3, 3
    v_bfe_u32 v25, v0, 4, 2
    v_and_b32 v26, 7, v0
    s_xor_b32 s90, s90, s68
    s_lshl_b32 s69, s90, 1
    s_or_b32 s69, s69, s89
    v_lshl_add_u32 v28, v31, 4, v24
    v_xor_b32 v27, v26, v25
    v_lshlrev_b32 v27, 4, v27
    v_lshl_add_u32 v1, v28, 10, v27
    s_mul_i32 s75, s68, 3
    s_mul_i32 s90, s69, 1
    s_add_u32 s75, s75, s90
    s_lshl_b32 s88, s70, 2
    s_and_b32 s75, s75, 7
    s_lshl_b32 s83, s72, 11
    s_lshl_b32 s100, s69, 17
    v_xor_b32 v2, 64, v1
    v_add_u32 v2, 0x2000, v2
    s_mov_b32 s92, 0x6420ba98
    s_mov_b32 s93, 0x420ba988
    s_lshr_b64 s[92:93], s[92:93], s88
    s_and_b32 s89, s92, 15
    s_and_b32 s77, s68, 1
    s_bitcmp0_b32 0xe1f0, s70
    s_mov_b32 s91, 2752
    s_cmov_b32 s91, 3072
    s_mov_b32 s93, 128
    s_cmov_b32 s93, 1024
    s_cselect_b32 s90, 4, 11
    s_mov_b32 s34, 1409024
    s_cmov_b32 s34, 1572864
    s_cselect_b32 s81, 0, 1
    s_mul_i32 s90, s90, s77
    s_add_u32 s85, s89, s90
    s_lshl_b32 s92, s85, 7
    s_sub_u32 s34, s34, s92
    v_lshl_add_u32 v27, v31, 3, v25
    v_mul_lo_u32 v3, v27, s91
    v_and_b32 v27, 15, v0
    v_lshlrev_b32 v28, 2, v25
    v_xor_b32 v27, v27, v28
    v_lshrrev_b32 v28, 3, v27
    v_mul_lo_u32 v28, v28, s93
    v_and_b32 v27, 7, v27
    v_lshl_add_u32 v28, v27, 4, v28
    v_add_u32 v3, v3, v28
    s_lshl_b32 s78, s91, 6
    s_lshl_b32 s79, s91, 2
    s_mov_b32 s30, 0x20000
    s_mov_b32 s31, 0x20000
    s_mov_b32 s35, 0x20000
    s_cmp_eq_u32 s81, 0
    s_waitcnt lgkmcnt(0)
    s_cselect_b32 s32, s6, s14
    s_cselect_b32 s33, s7, s15
    s_add_u32 s28, s4, s100
    s_addc_u32 s29, s5, 0
    s_add_u32 s32, s32, s92
    s_addc_u32 s33, s33, 0
    s_load_dwordx4 s[20:23], s[0:1], 64
    s_load_dwordx2 s[24:25], s[0:1], 80
    s_add_u32 s96, s75, 0
    s_and_b32 s96, s96, 7
    s_mul_i32 s97, s96, s78
    s_lshl_b32 s96, s96, 7
    s_add_u32 m0, s83, 0
    s_nop 0
    buffer_load_dwordx4 v1, s[28:31], s96 offen  lds
    s_add_u32 m0, s83, 49152
    s_nop 0
    buffer_load_dwordx4 v3, s[32:35], s97 offen lds
    s_add_u32 m0, s83, 1024
    s_nop 0
    buffer_load_dwordx4 v2, s[28:31], s96 offen  lds
    s_add_u32 s97, s97, s79
    s_add_u32 m0, s83, 50176
    s_nop 0
    buffer_load_dwordx4 v3, s[32:35], s97 offen lds
    s_getpc_b64 s[90:91]
L_pc:
    s_lshr_b32 s88, s2, 3
    s_lshl_b32 s88, s88, 3
    s_add_u32 s88, s88, s72
    s_mul_i32 s88, s88, 184
    s_min_u32 s88, s88, L_end-L_pc-68
    v_and_b32 v27, 1, v0
    v_lshlrev_b32 v27, 6, v27
    v_add_u32 v27, s88, v27
    global_load_dword v69, v27, s[90:91]
    v_and_b32 v0, 63, v0
    s_and_b32 s73, s72, 3
    s_lshr_b32 s74, s72, 2
    s_lshl_b32 s82, s72, 10
    s_lshl_b32 s88, s70, 2
    s_mov_b32 s92, 0x76543210
    s_mov_b32 s93, 0x32100
    s_lshr_b64 s[92:93], s[92:93], s88
    s_and_b32 s89, s92, 15
    s_lshl_b32 s90, s77, 2
    s_xor_b32 s13, s89, s90
    s_lshl_b32 s88, s70, 2
    s_mov_b32 s60, s8
    s_mov_b32 s61, s9
    s_mov_b32 s62, 16384
    s_mov_b32 s63, 0x20000
    s_waitcnt lgkmcnt(0)
    s_mov_b32 s9, s81
    s_mov_b32 s92, 0x11111111
    s_mov_b32 s93, 0x0
    s_lshr_b64 s[92:93], s[92:93], s88
    s_and_b32 s81, s92, 15
    s_mov_b32 s92, 0x0
    s_mov_b32 s93, 0x876aa99a
    s_lshr_b64 s[92:93], s[92:93], s88
    s_and_b32 s86, s92, 15
    s_mov_b32 s92, 0x17654230
    s_mov_b32 s93, 0x42317650
    s_lshr_b64 s[92:93], s[92:93], s88
    s_and_b32 s3, s92, 15
    s_mul_i32 s90, s77, 11
    s_add_u32 s86, s86, s90
    s_lshl_b32 s8, s90, 16
    s_cmp_eq_u32 s81, 1
    s_cselect_b32 s36, s6, s14
    s_cselect_b32 s37, s7, s15
    s_mov_b32 s38, 1409024
    s_cmov_b32 s38, 1572864
    s_mov_b32 s39, 0x20000
    s_mov_b32 s91, 2752
    s_cmov_b32 s91, 3072
    s_cselect_b32 s92, s13, s86
    s_lshl_b32 s80, s91, 6
    s_lshl_b32 s92, s92, 7
    s_mov_b32 s40, s16
    s_mov_b32 s41, s17
    s_mov_b32 s42, 1409024
    s_mov_b32 s43, 0x20000
    s_mov_b32 s44, s10
    s_mov_b32 s45, s11
    s_mov_b32 s46, 524288
    s_mov_b32 s47, 0x20000
    s_mov_b32 s48, s24
    s_mov_b32 s49, s25
    s_mov_b32 s50, 33554432
    s_mov_b32 s51, 0x20000
    s_mov_b32 s64, s22
    s_mov_b32 s65, s23
    s_mov_b32 s66, 256
    s_mov_b32 s67, 0x20000
    s_mov_b32 s16, s77
    s_and_b32 s93, s69, 1
    s_lshl_b32 s93, s93, 1
    s_add_u32 s15, s93, s9
    s_lshl_b32 s101, s68, 5
    v_and_b32 v27, 1, v25
    v_lshlrev_b32 v27, 2, v27
    v_xor_b32 v27, v27, v26
    v_lshlrev_b32 v27, 4, v27
    s_lshl_b32 s89, s72, 3
    v_add_u32 v28, s89, v24
    v_mul_lo_u32 v4, v28, s91
    v_add3_u32 v4, v4, v27, s92
    s_lshl_b32 s89, s3, 7
    v_lshl_add_u32 v12, v28, 10, v27
    v_add_u32 v12, s89, v12
    v_lshlrev_b32 v22, 4, v0
    s_add_u32 s96, s75, 1
    s_and_b32 s96, s96, 7
    s_mul_i32 s97, s96, s78
    s_lshl_b32 s96, s96, 7
    s_add_u32 m0, s83, 16384
    s_nop 0
    buffer_load_dwordx4 v1, s[28:31], s96 offen  lds
    v_lshrrev_b32 v24, 5, v0
    v_bfe_u32 v26, v0, 2, 2
    v_and_b32 v27, 1, v0
    v_bfe_u32 v28, v0, 1, 1
    v_lshl_add_u32 v27, v27, 1, v28
    v_lshlrev_b32 v27, 3, v27
    v_and_b32 v30, 1, v25
    v_lshl_add_u32 v27, v30, 5, v27
    v_lshl_add_u32 v28, v24, 3, v26
    v_xor_b32 v29, s74, v26
    v_lshlrev_b32 v29, 6, v29
    v_lshl_add_u32 v29, v28, 8, v29
    v_add_u32 v29, v29, v27
    v_add_u32 v9, 49152, v29
    v_xor_b32 v10, 128, v9
    v_and_b32 v31, 31, v0
    v_bfe_u32 v29, v0, 1, 3
    v_xor_b32 v29, v29, v24
    v_lshlrev_b32 v29, 4, v29
    s_lshl_b32 s88, s73, 12
    v_lshl_add_u32 v5, v31, 7, v29
    v_add_u32 v5, s88, v5
    v_xor_b32 v6, 32, v5
    v_xor_b32 v7, 64, v5
    v_xor_b32 v8, 0x60, v5
    s_add_u32 m0, s83, 65536
    s_nop 0
    buffer_load_dwordx4 v3, s[32:35], s97 offen lds
    v_lshrrev_b32 v29, 1, v26
    v_lshlrev_b32 v29, 6, v29
    v_lshl_add_u32 v29, v28, 7, v29
    v_add_u32 v29, v29, v27
    s_lshl_b32 s88, s74, 6
    v_xor_b32 v11, s88, v29
    v_add_u32 v11, 98304, v11
    s_lshr_b32 s88, s72, 1
    s_lshl_b32 s88, s88, 11
    v_add_u32 v13, s88, v29
    v_xor_b32 v14, 64, v13
    v_add_u32 v17, 98304, v13
    v_add_u32 v18, 98304, v14
    v_mul_u32_u24 v29, 480, v30
    v_add_u32 v29, v29, v27
    v_lshl_add_u32 v29, v28, 5, v29
    s_lshl_b32 s88, s74, 12
    s_add_u32 s88, s88, 155648
    v_add_u32 v67, s88, v29
    s_cmp_ge_u32 s3, 5
    s_cselect_b32 s88, 5, 0
    s_sub_u32 s5, s3, s88
    s_lshr_b32 s88, s8, 3
    s_lshl_b32 s89, s16, 21
    s_add_u32 s7, s88, s89
    s_xor_b32 s89, s89, 0x200000
    s_add_u32 s6, s88, s89
    s_mov_b32 s84, 0x3fb8aa3b
    s_mov_b32 s0, 0x3fb8aa3b
    s_mov_b32 s1, 0x3fb8aa3b
    s_add_u32 m0, s83, 17408
    s_nop 0
    buffer_load_dwordx4 v2, s[28:31], s96 offen  lds
    s_lshl_b32 s88, s70, 2
    s_mov_b32 s92, 0x32100000
    s_mov_b32 s93, 0x21055444
    s_lshr_b64 s[92:93], s[92:93], s88
    s_and_b32 s89, s92, 15
    s_lshl_b32 s90, s68, 1
    s_xor_b32 s93, s71, 1
    s_add_u32 s90, s90, s93
    s_lshl_b32 s90, s90, 1
    s_and_b32 s93, s69, 1
    s_add_u32 s90, s90, s93
    s_lshl_b32 s90, s90, 2
    s_add_u32 s90, s90, s73
    s_lshl_b32 s90, s90, 1
    s_add_u32 s90, s90, s74
    s_lshl_b32 s90, s90, 4
    s_add_u32 s90, s90, s89
    s_lshl_b32 s90, s90, 2
    s_add_u32 s14, s90, 18087936
    s_lshl_b32 s88, s15, 1
    s_and_b32 s89, s72, 1
    s_add_u32 s88, s88, s89
    s_lshr_b32 s89, s72, 1
    v_lshrrev_b32 v27, 3, v0
    v_cmp_eq_u32 vcc, 3, v27
    s_and_b32 s90, s88, 3
    s_add_u32 s90, s90, 9
    s_lshl_b32 s90, s90, 7
    v_add_u32 v27, s90, v22
    v_cndmask_b32 v27, v22, v27, vcc
    s_and_b32 s91, s68, 6
    s_lshl_b32 s91, s91, 3
    s_add_u32 s91, s91, s88
    s_lshl_b32 s90, s91, 18
    s_lshl_b32 s91, s89, 11
    s_add_u32 s90, s90, s91
    v_add_u32 v19, s90, v27
    s_add_u32 s90, s73, 9
    s_lshl_b32 s90, s90, 7
    v_add_u32 v27, s90, v22
    v_cndmask_b32 v20, v22, v27, vcc
    s_lshl_b32 s88, s88, 1
    s_lshr_b32 s89, s89, 1
    s_add_u32 s88, s88, s89
    s_lshl_b32 s88, s88, 6
    s_lshl_b32 s89, s68, 11
    s_add_u32 s89, s89, s88
    s_add_u32 s89, s89, 18087936
    s_lshl_b32 s90, s68, 10
    s_add_u32 s90, s90, s88
    s_add_u32 s90, s90, 18104320
    s_and_b32 s91, s15, 2
    s_add_u32 s91, s91, s74
    s_lshl_b32 s91, s91, 2
    s_and_b32 s92, s72, 1
    s_lshl_b32 s92, s92, 1
    s_add_u32 s91, s91, s92
    s_bfe_u32 s92, s72, 0x10001
    s_add_u32 s91, s91, s92
    s_lshl_b32 s91, s91, 6
    s_lshl_b32 s92, s68, 11
    s_add_u32 s91, s91, s92
    s_add_u32 s91, s91, 18088960
    s_mov_b32 s10, s89
    s_mov_b32 s11, s91
    v_and_b32 v27, 15, v0
    v_lshlrev_b32 v27, 2, v27
    v_add_u32 v28, s90, v27
    v_add_u32 v29, s91, v27
    v_add_u32 v27, s89, v27
    v_cmp_gt_u32 vcc, 32, v0
    s_nop 1
    v_cndmask_b32 v21, v28, v29, vcc
    v_cmp_gt_u32 vcc, 16, v0
    s_nop 1
    v_cndmask_b32 v21, v21, v27, vcc
    s_xor_b32 s88, s68, 1
    s_lshl_b32 s88, s88, 2
    s_add_u32 s88, s88, s15
    s_lshl_b32 s88, s88, 3
    s_add_u32 s88, s88, s3
    s_lshl_b32 s88, s88, 1
    s_and_b32 s92, s72, 1
    s_add_u32 s88, s88, s92
    s_lshl_b32 s88, s88, 6
    s_add_u32 s88, s88, 18219008
    s_sub_u32 s88, s88, s90
    v_add_u32 v28, s88, v28
    v_cmp_gt_u32 vcc, 48, v0
    s_nop 1
    v_cndmask_b32 v21, v28, v21, vcc
    s_lshl_b32 s88, s69, 2
    s_add_u32 s88, s88, s73
    s_lshl_b32 s88, s88, 18
    s_lshl_b32 s89, s74, 12
    s_add_u32 s88, s88, s89
    v_add_u32 v20, s88, v20
    s_add_u32 s97, s97, s79
    s_add_u32 m0, s83, 66560
    s_nop 0
    buffer_load_dwordx4 v3, s[32:35], s97 offen lds
    s_getreg_b32 s95, hwreg(HW_REG_XCC_ID, 0, 4)
    s_mul_i32 s90, s95, s95
    s_lshl_b32 s90, s90, 16
    s_lshl_b32 s91, s95, 8
    s_add_u32 s90, s90, s91
    s_add_u32 s90, s90, 1
    s_cmp_eq_u32 s72, 0
    s_cselect_b32 s88, s101, 0x1000
    v_mov_b32 v66, s90
    s_mov_b64 exec, 1
    buffer_atomic_add v66, off, s[64:67], s88
    s_mov_b64 exec, -1
    s_lshl_b32 s88, s70, 3
    s_add_u32 s88, s88, s72
    s_lshl_b32 s88, s88, 10
    s_add_u32 s89, s75, 3
    v_min_u32 v66, 4, v0
    v_add_u32 v66, s89, v66
    v_and_b32 v66, 7, v66
    v_lshlrev_b32 v66, 7, v66
    buffer_load_dword v69, v66, s[28:31], s88 offen
    s_add_u32 s96, s75, 2
    s_and_b32 s96, s96, 7
    s_mul_i32 s97, s96, s78
    s_lshl_b32 s96, s96, 7
    s_add_u32 m0, s83, 32768
    s_nop 0
    buffer_load_dwordx4 v1, s[28:31], s96 offen  lds
    s_add_u32 m0, s83, 81920
    s_nop 0
    buffer_load_dwordx4 v3, s[32:35], s97 offen lds
    s_waitcnt vmcnt(9)
    s_barrier
    ds_read_b128 a[0:3], v5 offset:0
    ds_read_b64_tr_b16 v[80:81], v9 offset:0
    ds_read_b64_tr_b16 v[82:83], v9 offset:1024
    ds_read_b64_tr_b16 v[84:85], v10 offset:0
    ds_read_b64_tr_b16 v[86:87], v10 offset:1024
    ds_read_b128 a[4:7], v6 offset:0
    ds_read_b64_tr_b16 v[88:89], v9 offset:4096
    ds_read_b64_tr_b16 v[90:91], v9 offset:5120
    ds_read_b64_tr_b16 v[92:93], v10 offset:4096
    ds_read_b64_tr_b16 v[94:95], v10 offset:5120
    s_add_u32 m0, s83, 33792
    s_nop 0
    buffer_load_dwordx4 v2, s[28:31], s96 offen  lds
    s_add_u32 s97, s97, s79
    s_add_u32 m0, s83, 82944
    s_nop 0
    buffer_load_dwordx4 v3, s[32:35], s97 offen lds
    s_waitcnt lgkmcnt(0)
    v_mfma_f32_32x32x16_bf16 v[32:47], v[80:83], a[0:3], 0
    ds_read_b128 a[8:11], v7 offset:0
    ds_read_b64_tr_b16 v[96:97], v9 offset:8192
    ds_read_b64_tr_b16 v[98:99], v9 offset:9216
    ds_read_b64_tr_b16 v[100:101], v10 offset:8192
    ds_read_b64_tr_b16 v[102:103], v10 offset:9216
    v_mfma_f32_32x32x16_bf16 v[48:63], v[84:87], a[0:3], 0
    ds_read_b128 a[12:15], v8 offset:0
    ds_read_b64_tr_b16 v[112:113], v9 offset:12288
    ds_read_b64_tr_b16 v[114:115], v9 offset:13312
    ds_read_b64_tr_b16 v[116:117], v10 offset:12288
    ds_read_b64_tr_b16 v[118:119], v10 offset:13312
    s_mov_b32 s88, 18153472
    buffer_load_dword v68, off, s[48:51], s88 sc1
    v_mfma_f32_32x32x16_bf16 v[32:47], v[88:91], a[4:7], v[32:47]
    s_lshl_b32 s88, s13, 11
    s_lshl_b32 s89, s74, 10
    s_add_u32 s88, s88, s89
    s_add_u32 m0, s82, 155648
    s_cmp_eq_u32 s73, 0
    s_cbranch_scc0 L_wp_1
    buffer_load_dwordx4 v22, s[60:63], s88 offen lds
    s_branch L_wpd_2
L_wp_1:
    buffer_load_dword v69, off, s[60:63], s88
L_wpd_2:
    v_mfma_f32_32x32x16_bf16 v[48:63], v[92:95], a[4:7], v[48:63]
    buffer_load_dword v69, v21, s[48:51], 0 offen sc1
    s_waitcnt lgkmcnt(0)
    s_waitcnt vmcnt(9)
    s_barrier
    v_mfma_f32_32x32x16_bf16 v[32:47], v[96:99], a[8:11], v[32:47]
    ds_read_b128 a[16:19], v5 offset:16384
    ds_read_b64_tr_b16 v[80:81], v9 offset:16384
    ds_read_b64_tr_b16 v[82:83], v9 offset:17408
    ds_read_b64_tr_b16 v[84:85], v10 offset:16384
    ds_read_b64_tr_b16 v[86:87], v10 offset:17408
    v_mfma_f32_32x32x16_bf16 v[48:63], v[100:103], a[8:11], v[48:63]
    ds_read_b128 a[20:23], v6 offset:16384
    ds_read_b64_tr_b16 v[88:89], v9 offset:20480
    ds_read_b64_tr_b16 v[90:91], v9 offset:21504
    ds_read_b64_tr_b16 v[92:93], v10 offset:20480
    ds_read_b64_tr_b16 v[94:95], v10 offset:21504
    s_add_u32 s96, s75, 3
    s_and_b32 s96, s96, 7
    s_mul_i32 s97, s96, s78
    s_lshl_b32 s96, s96, 7
    s_add_u32 m0, s83, 0
    s_nop 0
    buffer_load_dwordx4 v1, s[28:31], s96 offen  lds
    v_mfma_f32_32x32x16_bf16 v[32:47], v[112:115], a[12:15], v[32:47]
    s_add_u32 m0, s83, 49152
    s_nop 0
    buffer_load_dwordx4 v3, s[32:35], s97 offen lds
    v_mfma_f32_32x32x16_bf16 v[48:63], v[116:119], a[12:15], v[48:63]
    s_waitcnt lgkmcnt(0)
    v_mfma_f32_32x32x16_bf16 v[32:47], v[80:83], a[16:19], v[32:47]
    ds_read_b128 a[24:27], v7 offset:16384
    ds_read_b64_tr_b16 v[96:97], v9 offset:24576
    ds_read_b64_tr_b16 v[98:99], v9 offset:25600
    ds_read_b64_tr_b16 v[100:101], v10 offset:24576
    ds_read_b64_tr_b16 v[102:103], v10 offset:25600
    v_mfma_f32_32x32x16_bf16 v[48:63], v[84:87], a[16:19], v[48:63]
    ds_read_b128 a[28:31], v8 offset:16384
    ds_read_b64_tr_b16 v[112:113], v9 offset:28672
    ds_read_b64_tr_b16 v[114:115], v9 offset:29696
    ds_read_b64_tr_b16 v[116:117], v10 offset:28672
    ds_read_b64_tr_b16 v[118:119], v10 offset:29696
    s_add_u32 m0, s83, 1024
    s_nop 0
    buffer_load_dwordx4 v2, s[28:31], s96 offen  lds
    v_mfma_f32_32x32x16_bf16 v[32:47], v[88:91], a[20:23], v[32:47]
    s_add_u32 s97, s97, s79
    s_add_u32 m0, s83, 50176
    s_nop 0
    buffer_load_dwordx4 v3, s[32:35], s97 offen lds
    v_mfma_f32_32x32x16_bf16 v[48:63], v[92:95], a[20:23], v[48:63]
    s_waitcnt lgkmcnt(0)
    s_waitcnt vmcnt(7)
    s_barrier
    v_mfma_f32_32x32x16_bf16 v[32:47], v[96:99], a[24:27], v[32:47]
    ds_read_b128 a[32:35], v5 offset:32768
    ds_read_b64_tr_b16 v[80:81], v9 offset:32768
    ds_read_b64_tr_b16 v[82:83], v9 offset:33792
    ds_read_b64_tr_b16 v[84:85], v10 offset:32768
    ds_read_b64_tr_b16 v[86:87], v10 offset:33792
    v_mfma_f32_32x32x16_bf16 v[48:63], v[100:103], a[24:27], v[48:63]
    ds_read_b128 a[36:39], v6 offset:32768
    ds_read_b64_tr_b16 v[88:89], v9 offset:36864
    ds_read_b64_tr_b16 v[90:91], v9 offset:37888
    ds_read_b64_tr_b16 v[92:93], v10 offset:36864
    ds_read_b64_tr_b16 v[94:95], v10 offset:37888
    s_add_u32 s96, s75, 4
    s_and_b32 s96, s96, 7
    s_mul_i32 s97, s96, s78
    s_lshl_b32 s96, s96, 7
    s_add_u32 m0, s83, 16384
    s_nop 0
    buffer_load_dwordx4 v1, s[28:31], s96 offen  lds
    v_mfma_f32_32x32x16_bf16 v[32:47], v[112:115], a[28:31], v[32:47]
    s_add_u32 m0, s83, 65536
    s_nop 0
    buffer_load_dwordx4 v3, s[32:35], s97 offen lds
    v_mfma_f32_32x32x16_bf16 v[48:63], v[116:119], a[28:31], v[48:63]
    s_waitcnt lgkmcnt(0)
    v_mfma_f32_32x32x16_bf16 v[32:47], v[80:83], a[32:35], v[32:47]
    ds_read_b128 a[40:43], v7 offset:32768
    ds_read_b64_tr_b16 v[96:97], v9 offset:40960
    ds_read_b64_tr_b16 v[98:99], v9 offset:41984
    ds_read_b64_tr_b16 v[100:101], v10 offset:40960
    ds_read_b64_tr_b16 v[102:103], v10 offset:41984
    v_mfma_f32_32x32x16_bf16 v[48:63], v[84:87], a[32:35], v[48:63]
    ds_read_b128 a[44:47], v8 offset:32768
    ds_read_b64_tr_b16 v[112:113], v9 offset:45056
    ds_read_b64_tr_b16 v[114:115], v9 offset:46080
    ds_read_b64_tr_b16 v[116:117], v10 offset:45056
    ds_read_b64_tr_b16 v[118:119], v10 offset:46080
    s_add_u32 m0, s83, 17408
    s_nop 0
    buffer_load_dwordx4 v2, s[28:31], s96 offen  lds
    v_mfma_f32_32x32x16_bf16 v[32:47], v[88:91], a[36:39], v[32:47]
    s_add_u32 s97, s97, s79
    s_add_u32 m0, s83, 66560
    s_nop 0
    buffer_load_dwordx4 v3, s[32:35], s97 offen lds
    v_mfma_f32_32x32x16_bf16 v[48:63], v[92:95], a[36:39], v[48:63]
    s_waitcnt lgkmcnt(0)
    s_waitcnt vmcnt(4)
    s_barrier
    v_mfma_f32_32x32x16_bf16 v[32:47], v[96:99], a[40:43], v[32:47]
    ds_read_b128 a[48:51], v5 offset:0
    ds_read_b64_tr_b16 v[80:81], v9 offset:0
    ds_read_b64_tr_b16 v[82:83], v9 offset:1024
    ds_read_b64_tr_b16 v[84:85], v10 offset:0
    ds_read_b64_tr_b16 v[86:87], v10 offset:1024
    v_mfma_f32_32x32x16_bf16 v[48:63], v[100:103], a[40:43], v[48:63]
    ds_read_b128 a[52:55], v6 offset:0
    ds_read_b64_tr_b16 v[88:89], v9 offset:4096
    ds_read_b64_tr_b16 v[90:91], v9 offset:5120
    ds_read_b64_tr_b16 v[92:93], v10 offset:4096
    ds_read_b64_tr_b16 v[94:95], v10 offset:5120
    s_add_u32 s96, s75, 5
    s_and_b32 s96, s96, 7
    s_mul_i32 s97, s96, s78
    s_lshl_b32 s96, s96, 7
    s_add_u32 m0, s83, 32768
    s_nop 0
    buffer_load_dwordx4 v1, s[28:31], s96 offen  lds
    v_mfma_f32_32x32x16_bf16 v[32:47], v[112:115], a[44:47], v[32:47]
    s_add_u32 m0, s83, 81920
    s_nop 0
    buffer_load_dwordx4 v3, s[32:35], s97 offen lds
    v_mfma_f32_32x32x16_bf16 v[48:63], v[116:119], a[44:47], v[48:63]
    s_waitcnt lgkmcnt(0)
    v_mfma_f32_32x32x16_bf16 v[32:47], v[80:83], a[48:51], v[32:47]
    ds_read_b128 a[56:59], v7 offset:0
    ds_read_b64_tr_b16 v[96:97], v9 offset:8192
    ds_read_b64_tr_b16 v[98:99], v9 offset:9216
    ds_read_b64_tr_b16 v[100:101], v10 offset:8192
    ds_read_b64_tr_b16 v[102:103], v10 offset:9216
    v_mfma_f32_32x32x16_bf16 v[48:63], v[84:87], a[48:51], v[48:63]
    ds_read_b128 a[60:63], v8 offset:0
    ds_read_b64_tr_b16 v[112:113], v9 offset:12288
    ds_read_b64_tr_b16 v[114:115], v9 offset:13312
    ds_read_b64_tr_b16 v[116:117], v10 offset:12288
    ds_read_b64_tr_b16 v[118:119], v10 offset:13312
    s_add_u32 m0, s83, 33792
    s_nop 0
    buffer_load_dwordx4 v2, s[28:31], s96 offen  lds
    v_mfma_f32_32x32x16_bf16 v[32:47], v[88:91], a[52:55], v[32:47]
    s_add_u32 s97, s97, s79
    s_add_u32 m0, s83, 82944
    s_nop 0
    buffer_load_dwordx4 v3, s[32:35], s97 offen lds
    v_mfma_f32_32x32x16_bf16 v[48:63], v[92:95], a[52:55], v[48:63]
    s_waitcnt lgkmcnt(0)
    s_waitcnt vmcnt(4)
    s_barrier
    v_mfma_f32_32x32x16_bf16 v[32:47], v[96:99], a[56:59], v[32:47]
    ds_read_b128 a[64:67], v5 offset:16384
    ds_read_b64_tr_b16 v[80:81], v9 offset:16384
    ds_read_b64_tr_b16 v[82:83], v9 offset:17408
    ds_read_b64_tr_b16 v[84:85], v10 offset:16384
    ds_read_b64_tr_b16 v[86:87], v10 offset:17408
    v_mfma_f32_32x32x16_bf16 v[48:63], v[100:103], a[56:59], v[48:63]
    ds_read_b128 a[68:71], v6 offset:16384
    ds_read_b64_tr_b16 v[88:89], v9 offset:20480
    ds_read_b64_tr_b16 v[90:91], v9 offset:21504
    ds_read_b64_tr_b16 v[92:93], v10 offset:20480
    ds_read_b64_tr_b16 v[94:95], v10 offset:21504
    s_add_u32 s96, s75, 6
    s_and_b32 s96, s96, 7
    s_mul_i32 s97, s96, s78
    s_lshl_b32 s96, s96, 7
    s_add_u32 m0, s83, 0
    s_nop 0
    buffer_load_dwordx4 v1, s[28:31], s96 offen  lds
    v_mfma_f32_32x32x16_bf16 v[32:47], v[112:115], a[60:63], v[32:47]
    s_add_u32 m0, s83, 49152
    s_nop 0
    buffer_load_dwordx4 v3, s[32:35], s97 offen lds
    v_mfma_f32_32x32x16_bf16 v[48:63], v[116:119], a[60:63], v[48:63]
    s_add_u32 m0, s83, 1024
    s_nop 0
    buffer_load_dwordx4 v2, s[28:31], s96 offen  lds
    s_waitcnt lgkmcnt(0)
    v_mfma_f32_32x32x16_bf16 v[32:47], v[80:83], a[64:67], v[32:47]
    ds_read_b128 a[72:75], v7 offset:16384
    ds_read_b64_tr_b16 v[96:97], v9 offset:24576
    ds_read_b64_tr_b16 v[98:99], v9 offset:25600
    ds_read_b64_tr_b16 v[100:101], v10 offset:24576
    ds_read_b64_tr_b16 v[102:103], v10 offset:25600
    v_mfma_f32_32x32x16_bf16 v[48:63], v[84:87], a[64:67], v[48:63]
    ds_read_b128 a[76:79], v8 offset:16384
    ds_read_b64_tr_b16 v[112:113], v9 offset:28672
    ds_read_b64_tr_b16 v[114:115], v9 offset:29696
    ds_read_b64_tr_b16 v[116:117], v10 offset:28672
    ds_read_b64_tr_b16 v[118:119], v10 offset:29696
    s_add_u32 s97, s97, s79
    s_add_u32 m0, s83, 50176
    s_nop 0
    buffer_load_dwordx4 v3, s[32:35], s97 offen lds
    v_mfma_f32_32x32x16_bf16 v[32:47], v[88:91], a[68:71], v[32:47]
    s_add_u32 s100, s75, 0
    s_and_b32 s100, s100, 7
    s_mul_i32 s100, s100, s80
    s_add_u32 m0, s82, 98304
    s_nop 0
    buffer_load_dwordx4 v4, s[36:39], s100 offen lds
    v_mfma_f32_32x32x16_bf16 v[48:63], v[92:95], a[68:71], v[48:63]
    ds_read_b64_tr_b16 v[104:105], v67
    ds_read_b64_tr_b16 v[106:107], v67 offset:128
    v_readfirstlane_b32 s87, v68
    v_and_b32 v24, 16, v0
    v_cmp_eq_u32 vcc, 0, v24
    s_add_u32 s87, s87, 1
    s_mul_i32 s76, s87, 0x9E3779B1
    s_add_u32 s76, s76, 0x7F4A7C15
    s_waitcnt lgkmcnt(0)
    s_waitcnt vmcnt(5)
    s_barrier
    v_mfma_f32_32x32x16_bf16 v[32:47], v[96:99], a[72:75], v[32:47]
    ds_read_b128 a[80:83], v5 offset:32768
    ds_read_b64_tr_b16 v[80:81], v9 offset:32768
    ds_read_b64_tr_b16 v[82:83], v9 offset:33792
    ds_read_b64_tr_b16 v[84:85], v10 offset:32768
    ds_read_b64_tr_b16 v[86:87], v10 offset:33792
    v_mfma_f32_32x32x16_bf16 v[48:63], v[100:103], a[72:75], v[48:63]
    ds_read_b128 a[84:87], v6 offset:32768
    ds_read_b64_tr_b16 v[88:89], v9 offset:36864
    ds_read_b64_tr_b16 v[90:91], v9 offset:37888
    ds_read_b64_tr_b16 v[92:93], v10 offset:36864
    ds_read_b64_tr_b16 v[94:95], v10 offset:37888
    s_add_u32 s96, s75, 7
    s_and_b32 s96, s96, 7
    s_mul_i32 s97, s96, s78
    s_lshl_b32 s96, s96, 7
    s_add_u32 m0, s83, 16384
    s_nop 0
    buffer_load_dwordx4 v1, s[28:31], s96 offen  lds
    v_mfma_f32_32x32x16_bf16 v[32:47], v[112:115], a[76:79], v[32:47]
    s_add_u32 m0, s83, 65536
    s_nop 0
    buffer_load_dwordx4 v3, s[32:35], s97 offen lds
    v_mfma_f32_32x32x16_bf16 v[48:63], v[116:119], a[76:79], v[48:63]
    s_add_u32 m0, s83, 17408
    s_nop 0
    buffer_load_dwordx4 v2, s[28:31], s96 offen  lds
    v_cndmask_b32_e64 v108, v104, 0, vcc
    v_cndmask_b32 v104, 0, v104, vcc
    v_cndmask_b32_e64 v109, v105, 0, vcc
    v_cndmask_b32 v105, 0, v105, vcc
    v_cndmask_b32_e64 v110, v106, 0, vcc
    v_cndmask_b32 v106, 0, v106, vcc
    v_cndmask_b32_e64 v111, v107, 0, vcc
    v_cndmask_b32 v107, 0, v107, vcc
    s_waitcnt lgkmcnt(0)
    v_mfma_f32_32x32x16_bf16 v[32:47], v[80:83], a[80:83], v[32:47]
    ds_read_b128 a[88:91], v7 offset:32768
    ds_read_b64_tr_b16 v[96:97], v9 offset:40960
    ds_read_b64_tr_b16 v[98:99], v9 offset:41984
    ds_read_b64_tr_b16 v[100:101], v10 offset:40960
    ds_read_b64_tr_b16 v[102:103], v10 offset:41984
    v_mfma_f32_32x32x16_bf16 v[48:63], v[84:87], a[80:83], v[48:63]
    ds_read_b128 a[92:95], v8 offset:32768
    ds_read_b64_tr_b16 v[112:113], v9 offset:45056
    ds_read_b64_tr_b16 v[114:115], v9 offset:46080
    ds_read_b64_tr_b16 v[116:117], v10 offset:45056
    ds_read_b64_tr_b16 v[118:119], v10 offset:46080
    s_add_u32 s97, s97, s79
    s_add_u32 m0, s83, 66560
    s_nop 0
    buffer_load_dwordx4 v3, s[32:35], s97 offen lds
    v_mfma_f32_32x32x16_bf16 v[32:47], v[88:91], a[84:87], v[32:47]
    s_add_u32 s100, s75, 1
    s_and_b32 s100, s100, 7
    s_mul_i32 s100, s100, s80
    s_add_u32 m0, s82, 106496
    s_nop 0
    buffer_load_dwordx4 v4, s[36:39], s100 offen lds
    v_mfma_f32_32x32x16_bf16 v[48:63], v[92:95], a[84:87], v[48:63]
    s_waitcnt lgkmcnt(0)
    s_waitcnt vmcnt(6)
    s_barrier
    v_mfma_f32_32x32x16_bf16 v[32:47], v[96:99], a[88:91], v[32:47]
    ds_read_b128 a[96:99], v5 offset:0
    ds_read_b64_tr_b16 v[80:81], v9 offset:0
    ds_read_b64_tr_b16 v[82:83], v9 offset:1024
    ds_read_b64_tr_b16 v[84:85], v10 offset:0
    ds_read_b64_tr_b16 v[86:87], v10 offset:1024
    v_mfma_f32_32x32x16_bf16 v[48:63], v[100:103], a[88:91], v[48:63]
    ds_read_b128 a[100:103], v6 offset:0
    ds_read_b64_tr_b16 v[88:89], v9 offset:4096
    ds_read_b64_tr_b16 v[90:91], v9 offset:5120
    ds_read_b64_tr_b16 v[92:93], v10 offset:4096
    ds_read_b64_tr_b16 v[94:95], v10 offset:5120
    s_add_u32 s100, s75, 2
    s_and_b32 s100, s100, 7
    s_mul_i32 s100, s100, s80
    s_add_u32 m0, s82, 114688
    s_nop 0
    buffer_load_dwordx4 v4, s[36:39], s100 offen lds
    v_mfma_f32_32x32x16_bf16 v[32:47], v[112:115], a[92:95], v[32:47]
    s_add_u32 s100, s75, 3
    s_and_b32 s100, s100, 7
    s_mul_i32 s100, s100, s80
    s_add_u32 m0, s82, 122880
    s_nop 0
    buffer_load_dwordx4 v4, s[36:39], s100 offen lds
    v_mfma_f32_32x32x16_bf16 v[48:63], v[116:119], a[92:95], v[48:63]
    s_waitcnt lgkmcnt(0)
    v_mfma_f32_32x32x16_bf16 v[32:47], v[80:83], a[96:99], v[32:47]
    ds_read_b128 a[104:107], v7 offset:0
    ds_read_b64_tr_b16 v[96:97], v9 offset:8192
    ds_read_b64_tr_b16 v[98:99], v9 offset:9216
    ds_read_b64_tr_b16 v[100:101], v10 offset:8192
    ds_read_b64_tr_b16 v[102:103], v10 offset:9216
    v_mfma_f32_32x32x16_bf16 v[48:63], v[84:87], a[96:99], v[48:63]
    ds_read_b128 a[108:111], v8 offset:0
    ds_read_b64_tr_b16 v[112:113], v9 offset:12288
    ds_read_b64_tr_b16 v[114:115], v9 offset:13312
    ds_read_b64_tr_b16 v[116:117], v10 offset:12288
    ds_read_b64_tr_b16 v[118:119], v10 offset:13312
    s_add_u32 s100, s75, 4
    s_and_b32 s100, s100, 7
    s_mul_i32 s100, s100, s80
    s_add_u32 m0, s82, 131072
    s_nop 0
    buffer_load_dwordx4 v4, s[36:39], s100 offen lds
    v_mfma_f32_32x32x16_bf16 v[32:47], v[88:91], a[100:103], v[32:47]
    v_mfma_f32_32x32x16_bf16 v[48:63], v[92:95], a[100:103], v[48:63]
    s_waitcnt lgkmcnt(0)
    s_waitcnt vmcnt(4)
    s_barrier
    v_mfma_f32_32x32x16_bf16 v[32:47], v[96:99], a[104:107], v[32:47]
    ds_read_b128 a[112:115], v5 offset:16384
    ds_read_b64_tr_b16 v[80:81], v9 offset:16384
    ds_read_b64_tr_b16 v[82:83], v9 offset:17408
    ds_read_b64_tr_b16 v[84:85], v10 offset:16384
    ds_read_b64_tr_b16 v[86:87], v10 offset:17408
    v_mfma_f32_32x32x16_bf16 v[48:63], v[100:103], a[104:107], v[48:63]
    ds_read_b128 a[116:119], v6 offset:16384
    ds_read_b64_tr_b16 v[88:89], v9 offset:20480
    ds_read_b64_tr_b16 v[90:91], v9 offset:21504
    ds_read_b64_tr_b16 v[92:93], v10 offset:20480
    ds_read_b64_tr_b16 v[94:95], v10 offset:21504
    s_add_u32 s100, s75, 5
    s_and_b32 s100, s100, 7
    s_mul_i32 s100, s100, s80
    s_add_u32 m0, s82, 139264
    s_nop 0
    buffer_load_dwordx4 v4, s[36:39], s100 offen lds
    v_mfma_f32_32x32x16_bf16 v[32:47], v[112:115], a[108:111], v[32:47]
    s_add_u32 s100, s75, 6
    s_and_b32 s100, s100, 7
    s_mul_i32 s100, s100, s80
    s_add_u32 m0, s82, 147456
    s_nop 0
    buffer_load_dwordx4 v4, s[36:39], s100 offen lds
    v_mfma_f32_32x32x16_bf16 v[48:63], v[116:119], a[108:111], v[48:63]
    s_waitcnt lgkmcnt(0)
    v_mfma_f32_32x32x16_bf16 v[32:47], v[80:83], a[112:115], v[32:47]
    ds_read_b128 a[120:123], v7 offset:16384
    ds_read_b64_tr_b16 v[96:97], v9 offset:24576
    ds_read_b64_tr_b16 v[98:99], v9 offset:25600
    ds_read_b64_tr_b16 v[100:101], v10 offset:24576
    ds_read_b64_tr_b16 v[102:103], v10 offset:25600
    v_mfma_f32_32x32x16_bf16 v[48:63], v[84:87], a[112:115], v[48:63]
    ds_read_b128 a[124:127], v8 offset:16384
    ds_read_b64_tr_b16 v[112:113], v9 offset:28672
    ds_read_b64_tr_b16 v[114:115], v9 offset:29696
    ds_read_b64_tr_b16 v[116:117], v10 offset:28672
    ds_read_b64_tr_b16 v[118:119], v10 offset:29696
    s_add_u32 s100, s75, 7
    s_and_b32 s100, s100, 7
    s_mul_i32 s100, s100, s80
    s_add_u32 m0, s82, 155648
    s_nop 0
    buffer_load_dwordx4 v4, s[36:39], s100 offen lds
    v_mfma_f32_32x32x16_bf16 v[32:47], v[88:91], a[116:119], v[32:47]
    v_mfma_f32_32x32x16_bf16 v[48:63], v[92:95], a[116:119], v[48:63]
    s_waitcnt lgkmcnt(0)
    s_waitcnt vmcnt(4)
    s_barrier
    v_mfma_f32_32x32x16_bf16 v[32:47], v[96:99], a[120:123], v[32:47]
    v_mfma_f32_32x32x16_bf16 v[48:63], v[100:103], a[120:123], v[48:63]
    s_add_u32 s96, s15, 0
    s_cmp_ge_u32 s96, 5
    s_cselect_b32 s97, 5, 0
    s_sub_u32 s96, s96, s97
    s_lshl_b32 s97, s96, 13
    s_add_u32 s97, s97, s82
    s_lshl_b32 s96, s96, 16
    s_add_u32 s96, s96, s8
    s_add_u32 m0, s97, 8192
    s_nop 0
    buffer_load_dwordx4 v12, s[40:43], s96 offen lds
    v_mfma_f32_32x32x16_bf16 v[32:47], v[112:115], a[124:127], v[32:47]
    s_add_u32 s96, s15, 1
    s_cmp_ge_u32 s96, 5
    s_cselect_b32 s97, 5, 0
    s_sub_u32 s96, s96, s97
    s_lshl_b32 s97, s96, 13
    s_add_u32 s97, s97, s82
    s_lshl_b32 s96, s96, 16
    s_add_u32 s96, s96, s8
    s_add_u32 m0, s97, 8192
    s_nop 0
    buffer_load_dwordx4 v12, s[40:43], s96 offen lds
    v_mfma_f32_32x32x16_bf16 v[48:63], v[116:119], a[124:127], v[48:63]
    s_cmp_eq_u32 s9, 0
    s_cbranch_scc1 L_kv
    s_lshl_b32 s88, s85, 13
    ds_read_b64_tr_b16 v[80:81], v11 offset:0
    ds_read_b64_tr_b16 v[82:83], v11 offset:512
    ds_read_b64_tr_b16 v[84:85], v11 offset:2048
    ds_read_b64_tr_b16 v[86:87], v11 offset:2560
    ds_read_b64_tr_b16 v[88:89], v11 offset:4096
    ds_read_b64_tr_b16 v[90:91], v11 offset:4608
    v_max_f32 v32, 0, v32
    v_max_f32 v33, 0, v33
    v_cvt_pk_bf16_f32 v112, v32, v33
    v_max_f32 v34, 0, v34
    v_max_f32 v35, 0, v35
    v_cvt_pk_bf16_f32 v113, v34, v35
    v_max_f32 v36, 0, v36
    v_max_f32 v37, 0, v37
    s_waitcnt lgkmcnt(4)
    v_mfma_f32_32x32x16_bf16 v[64:79], v[80:83], a[0:3], 0
    ds_read_b64_tr_b16 v[92:93], v11 offset:6144
    ds_read_b64_tr_b16 v[94:95], v11 offset:6656
    v_cvt_pk_bf16_f32 v114, v36, v37
    v_max_f32 v38, 0, v38
    v_max_f32 v39, 0, v39
    v_cvt_pk_bf16_f32 v115, v38, v39
    s_add_u32 s89, s88, 0
    buffer_store_dwordx4 v[112:115], v20, s[48:51], s89 offen sc1
    v_max_f32 v40, 0, v40
    v_max_f32 v41, 0, v41
    s_waitcnt lgkmcnt(4)
    v_mfma_f32_32x32x16_bf16 v[64:79], v[84:87], a[4:7], v[64:79]
    ds_read_b64_tr_b16 v[80:81], v11 offset:8192
    ds_read_b64_tr_b16 v[82:83], v11 offset:8704
    v_cvt_pk_bf16_f32 v116, v40, v41
    v_max_f32 v42, 0, v42
    v_max_f32 v43, 0, v43
    v_cvt_pk_bf16_f32 v117, v42, v43
    v_max_f32 v44, 0, v44
    v_max_f32 v45, 0, v45
    v_cvt_pk_bf16_f32 v118, v44, v45
    v_max_f32 v46, 0, v46
    s_waitcnt lgkmcnt(4)
    v_mfma_f32_32x32x16_bf16 v[64:79], v[88:91], a[8:11], v[64:79]
    ds_read_b64_tr_b16 v[84:85], v11 offset:10240
    ds_read_b64_tr_b16 v[86:87], v11 offset:10752
    v_max_f32 v47, 0, v47
    v_cvt_pk_bf16_f32 v119, v46, v47
    s_add_u32 s89, s88, 2048
    buffer_store_dwordx4 v[116:119], v20, s[48:51], s89 offen sc1
    v_max_f32 v48, 0, v48
    v_max_f32 v49, 0, v49
    v_cvt_pk_bf16_f32 v120, v48, v49
    v_max_f32 v50, 0, v50
    s_waitcnt lgkmcnt(4)
    v_mfma_f32_32x32x16_bf16 v[64:79], v[92:95], a[12:15], v[64:79]
    ds_read_b64_tr_b16 v[88:89], v11 offset:12288
    ds_read_b64_tr_b16 v[90:91], v11 offset:12800
    v_max_f32 v51, 0, v51
    v_cvt_pk_bf16_f32 v121, v50, v51
    v_max_f32 v52, 0, v52
    v_max_f32 v53, 0, v53
    v_cvt_pk_bf16_f32 v122, v52, v53
    v_max_f32 v54, 0, v54
    v_max_f32 v55, 0, v55
    v_cvt_pk_bf16_f32 v123, v54, v55
    s_waitcnt lgkmcnt(4)
    v_mfma_f32_32x32x16_bf16 v[64:79], v[80:83], a[16:19], v[64:79]
    ds_read_b64_tr_b16 v[92:93], v11 offset:14336
    ds_read_b64_tr_b16 v[94:95], v11 offset:14848
    s_add_u32 s89, s88, 8192
    buffer_store_dwordx4 v[120:123], v20, s[48:51], s89 offen sc1
    v_max_f32 v56, 0, v56
    v_max_f32 v57, 0, v57
    v_cvt_pk_bf16_f32 v124, v56, v57
    v_max_f32 v58, 0, v58
    v_max_f32 v59, 0, v59
    v_cvt_pk_bf16_f32 v125, v58, v59
    s_waitcnt lgkmcnt(4)
    v_mfma_f32_32x32x16_bf16 v[64:79], v[84:87], a[20:23], v[64:79]
    ds_read_b64_tr_b16 v[80:81], v11 offset:16384
    ds_read_b64_tr_b16 v[82:83], v11 offset:16896
    v_max_f32 v60, 0, v60
    v_max_f32 v61, 0, v61
    v_cvt_pk_bf16_f32 v126, v60, v61
    v_max_f32 v62, 0, v62
    v_max_f32 v63, 0, v63
    v_cvt_pk_bf16_f32 v127, v62, v63
    s_add_u32 s89, s88, 10240
    buffer_store_dwordx4 v[124:127], v20, s[48:51], s89 offen sc1
    s_waitcnt lgkmcnt(4)
    v_mfma_f32_32x32x16_bf16 v[64:79], v[88:91], a[24:27], v[64:79]
    ds_read_b64_tr_b16 v[84:85], v11 offset:18432
    ds_read_b64_tr_b16 v[86:87], v11 offset:18944
    s_lshl_b32 s88, s2, 2
    s_add_u32 s88, s88, 18120704
    s_cmp_eq_u32 s72, 0
    s_cselect_b32 s88, s88, 2147483632
    v_mov_b32 v25, s76
    s_mov_b64 exec, 1
    buffer_store_dword v25, off, s[48:51], s88 sc1
    s_mov_b64 exec, -1
    s_lshl_b32 s88, s68, 5
    buffer_load_dword v31, off, s[64:67], s88 sc1
    s_waitcnt lgkmcnt(4)
    v_mfma_f32_32x32x16_bf16 v[64:79], v[92:95], a[28:31], v[64:79]
    ds_read_b64_tr_b16 v[88:89], v11 offset:20480
    ds_read_b64_tr_b16 v[90:91], v11 offset:20992
    s_waitcnt lgkmcnt(4)
    v_mfma_f32_32x32x16_bf16 v[64:79], v[80:83], a[32:35], v[64:79]
    ds_read_b64_tr_b16 v[92:93], v11 offset:22528
    ds_read_b64_tr_b16 v[94:95], v11 offset:23040
    s_waitcnt lgkmcnt(4)
    v_mfma_f32_32x32x16_bf16 v[64:79], v[84:87], a[36:39], v[64:79]
    ds_read_b64_tr_b16 v[80:81], v11 offset:24576
    ds_read_b64_tr_b16 v[82:83], v11 offset:25088
    s_waitcnt lgkmcnt(4)
    v_mfma_f32_32x32x16_bf16 v[64:79], v[88:91], a[40:43], v[64:79]
    ds_read_b64_tr_b16 v[84:85], v11 offset:26624
    ds_read_b64_tr_b16 v[86:87], v11 offset:27136
    s_waitcnt lgkmcnt(4)
    v_mfma_f32_32x32x16_bf16 v[64:79], v[92:95], a[44:47], v[64:79]
    ds_read_b64_tr_b16 v[88:89], v11 offset:28672
    ds_read_b64_tr_b16 v[90:91], v11 offset:29184
    s_waitcnt lgkmcnt(4)
    v_mfma_f32_32x32x16_bf16 v[64:79], v[80:83], a[48:51], v[64:79]
    ds_read_b64_tr_b16 v[92:93], v11 offset:30720
    ds_read_b64_tr_b16 v[94:95], v11 offset:31232
    s_waitcnt lgkmcnt(4)
    v_mfma_f32_32x32x16_bf16 v[64:79], v[84:87], a[52:55], v[64:79]
    s_waitcnt lgkmcnt(2)
    v_mfma_f32_32x32x16_bf16 v[64:79], v[88:91], a[56:59], v[64:79]
    s_waitcnt lgkmcnt(0)
    v_mfma_f32_32x32x16_bf16 v[64:79], v[92:95], a[60:63], v[64:79]
    s_waitcnt vmcnt(8)
    s_barrier
    s_cmp_eq_u32 s81, 1
    s_cbranch_scc1 L_hq
    ds_read_b64_tr_b16 v[80:81], v11 offset:32768
    ds_read_b64_tr_b16 v[82:83], v11 offset:33280
    ds_read_b64_tr_b16 v[84:85], v11 offset:34816
    ds_read_b64_tr_b16 v[86:87], v11 offset:35328
    ds_read_b64_tr_b16 v[88:89], v11 offset:36864
    ds_read_b64_tr_b16 v[90:91], v11 offset:37376
    s_waitcnt lgkmcnt(4)
    v_mfma_f32_32x32x16_bf16 v[64:79], v[80:83], a[64:67], v[64:79]
    ds_read_b64_tr_b16 v[92:93], v11 offset:38912
    ds_read_b64_tr_b16 v[94:95], v11 offset:39424
    s_waitcnt lgkmcnt(4)
    v_mfma_f32_32x32x16_bf16 v[64:79], v[84:87], a[68:71], v[64:79]
    ds_read_b64_tr_b16 v[80:81], v11 offset:40960
    ds_read_b64_tr_b16 v[82:83], v11 offset:41472
    s_add_u32 s96, s15, 2
    s_cmp_ge_u32 s96, 5
    s_cselect_b32 s97, 5, 0
    s_sub_u32 s96, s96, s97
    s_lshl_b32 s97, s96, 13
    s_add_u32 s97, s97, s82
    s_lshl_b32 s96, s96, 16
    s_add_u32 s96, s96, s8
    s_add_u32 m0, s97, 8192
    s_nop 0
    buffer_load_dwordx4 v12, s[40:43], s96 offen lds
    s_waitcnt lgkmcnt(4)
    v_mfma_f32_32x32x16_bf16 v[64:79], v[88:91], a[72:75], v[64:79]
    ds_read_b64_tr_b16 v[84:85], v11 offset:43008
    ds_read_b64_tr_b16 v[86:87], v11 offset:43520
    s_waitcnt lgkmcnt(4)
    v_mfma_f32_32x32x16_bf16 v[64:79], v[92:95], a[76:79], v[64:79]
    ds_read_b64_tr_b16 v[88:89], v11 offset:45056
    ds_read_b64_tr_b16 v[90:91], v11 offset:45568
    s_waitcnt lgkmcnt(4)
    v_mfma_f32_32x32x16_bf16 v[64:79], v[80:83], a[80:83], v[64:79]
    ds_read_b64_tr_b16 v[92:93], v11 offset:47104
    ds_read_b64_tr_b16 v[94:95], v11 offset:47616
    s_add_u32 s96, s15, 3
    s_cmp_ge_u32 s96, 5
    s_cselect_b32 s97, 5, 0
    s_sub_u32 s96, s96, s97
    s_lshl_b32 s97, s96, 13
    s_add_u32 s97, s97, s82
    s_lshl_b32 s96, s96, 16
    s_add_u32 s96, s96, s8
    s_add_u32 m0, s97, 8192
    s_nop 0
    buffer_load_dwordx4 v12, s[40:43], s96 offen lds
    s_waitcnt lgkmcnt(4)
    v_mfma_f32_32x32x16_bf16 v[64:79], v[84:87], a[84:87], v[64:79]
    ds_read_b64_tr_b16 v[80:81], v11 offset:49152
    ds_read_b64_tr_b16 v[82:83], v11 offset:49664
    s_waitcnt lgkmcnt(4)
    v_mfma_f32_32x32x16_bf16 v[64:79], v[88:91], a[88:91], v[64:79]
    ds_read_b64_tr_b16 v[84:85], v11 offset:51200
    ds_read_b64_tr_b16 v[86:87], v11 offset:51712
    s_waitcnt lgkmcnt(4)
    v_mfma_f32_32x32x16_bf16 v[64:79], v[92:95], a[92:95], v[64:79]
    ds_read_b64_tr_b16 v[88:89], v11 offset:53248
    ds_read_b64_tr_b16 v[90:91], v11 offset:53760
    s_add_u32 s96, s15, 4
    s_cmp_ge_u32 s96, 5
    s_cselect_b32 s97, 5, 0
    s_sub_u32 s96, s96, s97
    s_lshl_b32 s97, s96, 13
    s_add_u32 s97, s97, s82
    s_lshl_b32 s96, s96, 16
    s_add_u32 s96, s96, s8
    s_add_u32 m0, s97, 8192
    s_nop 0
    buffer_load_dwordx4 v12, s[40:43], s96 offen lds
    s_waitcnt lgkmcnt(4)
    v_mfma_f32_32x32x16_bf16 v[64:79], v[80:83], a[96:99], v[64:79]
    ds_read_b64_tr_b16 v[92:93], v11 offset:55296
    ds_read_b64_tr_b16 v[94:95], v11 offset:55808
    s_waitcnt lgkmcnt(4)
    v_mfma_f32_32x32x16_bf16 v[64:79], v[84:87], a[100:103], v[64:79]
    ds_read_b64_tr_b16 v[80:81], v11 offset:57344
    ds_read_b64_tr_b16 v[82:83], v11 offset:57856
    s_waitcnt vmcnt(3)
    s_mov_b32 s94, 40000
L_gm_3:
    v_readfirstlane_b32 s89, v31
    s_nop 1
    s_and_b32 s90, s89, 31
    s_cselect_b32 s90, 0, s89
    s_cmp_lg_u32 s90, 0
    s_cbranch_scc1 L_gmd_4
    s_sub_u32 s94, s94, 1
    s_cbranch_scc1 L_gmd_4
    s_lshl_b32 s88, s68, 5
    buffer_load_dword v31, off, s[64:67], s88 sc1
    s_waitcnt vmcnt(0)
    s_branch L_gm_3
L_gmd_4:
    s_mul_i32 s90, s95, s95
    s_lshl_b32 s90, s90, 16
    s_lshl_b32 s91, s95, 8
    s_add_u32 s90, s90, s91
    s_add_u32 s90, s90, 1
    s_lshl_b32 s90, s90, 5
    s_cmp_eq_u32 s89, s90
    s_cselect_b32 s77, 1, 0
    s_add_u32 s88, s14, 0
    v_mov_b32 v25, s76
    s_mov_b64 exec, 1
    s_cmp_eq_u32 s77, 1
    s_cbranch_scc0 L_sl_5
    buffer_store_dword v25, off, s[48:51], s88
    s_branch L_sd_6
L_sl_5:
    buffer_store_dword v25, off, s[48:51], s88 sc1
L_sd_6:
    s_mov_b64 exec, -1
    s_waitcnt lgkmcnt(4)
    v_mfma_f32_32x32x16_bf16 v[64:79], v[88:91], a[104:107], v[64:79]
    ds_read_b64_tr_b16 v[84:85], v11 offset:59392
    ds_read_b64_tr_b16 v[86:87], v11 offset:59904
    s_add_u32 s96, s15, 0
    s_add_u32 s96, s96, s15
    s_cmp_ge_u32 s96, 6
    s_cselect_b32 s97, 6, 0
    s_sub_u32 s96, s96, s97
    s_cmp_ge_u32 s96, 6
    s_cselect_b32 s97, 6, 0
    s_sub_u32 s96, s96, s97
    s_lshl_b32 s97, s96, 13
    s_add_u32 s97, s97, s82
    s_lshl_b32 s96, s96, 16
    s_add_u32 s96, s96, s8
    s_add_u32 s96, s96, 327680
    s_add_u32 m0, s97, 49152
    s_nop 0
    buffer_load_dwordx4 v12, s[40:43], s96 offen lds
    s_waitcnt lgkmcnt(4)
    v_mfma_f32_32x32x16_bf16 v[64:79], v[92:95], a[108:111], v[64:79]
    ds_read_b64_tr_b16 v[88:89], v11 offset:61440
    ds_read_b64_tr_b16 v[90:91], v11 offset:61952
    s_waitcnt lgkmcnt(4)
    v_mfma_f32_32x32x16_bf16 v[64:79], v[80:83], a[112:115], v[64:79]
    ds_read_b64_tr_b16 v[92:93], v11 offset:63488
    ds_read_b64_tr_b16 v[94:95], v11 offset:64000
    s_waitcnt lgkmcnt(4)
    v_mfma_f32_32x32x16_bf16 v[64:79], v[84:87], a[116:119], v[64:79]
    s_add_u32 s96, s15, 1
    s_add_u32 s96, s96, s15
    s_cmp_ge_u32 s96, 6
    s_cselect_b32 s97, 6, 0
    s_sub_u32 s96, s96, s97
    s_cmp_ge_u32 s96, 6
    s_cselect_b32 s97, 6, 0
    s_sub_u32 s96, s96, s97
    s_lshl_b32 s97, s96, 13
    s_add_u32 s97, s97, s82
    s_lshl_b32 s96, s96, 16
    s_add_u32 s96, s96, s8
    s_add_u32 s96, s96, 327680
    s_add_u32 m0, s97, 49152
    s_nop 0
    buffer_load_dwordx4 v12, s[40:43], s96 offen lds
    s_waitcnt lgkmcnt(2)
    v_mfma_f32_32x32x16_bf16 v[64:79], v[88:91], a[120:123], v[64:79]
    s_waitcnt lgkmcnt(0)
    v_mfma_f32_32x32x16_bf16 v[64:79], v[92:95], a[124:127], v[64:79]
    s_add_u32 s96, s15, 2
    s_add_u32 s96, s96, s15
    s_cmp_ge_u32 s96, 6
    s_cselect_b32 s97, 6, 0
    s_sub_u32 s96, s96, s97
    s_cmp_ge_u32 s96, 6
    s_cselect_b32 s97, 6, 0
    s_sub_u32 s96, s96, s97
    s_lshl_b32 s97, s96, 13
    s_add_u32 s97, s97, s82
    s_lshl_b32 s96, s96, 16
    s_add_u32 s96, s96, s8
    s_add_u32 s96, s96, 327680
    s_add_u32 m0, s97, 49152
    s_nop 0
    buffer_load_dwordx4 v12, s[40:43], s96 offen lds
    s_barrier
    s_add_u32 s96, s15, 3
    s_add_u32 s96, s96, s15
    s_cmp_ge_u32 s96, 6
    s_cselect_b32 s97, 6, 0
    s_sub_u32 s96, s96, s97
    s_cmp_ge_u32 s96, 6
    s_cselect_b32 s97, 6, 0
    s_sub_u32 s96, s96, s97
    s_lshl_b32 s97, s96, 13
    s_add_u32 s97, s97, s82
    s_lshl_b32 s96, s96, 16
    s_add_u32 s96, s96, s8
    s_add_u32 s96, s96, 327680
    s_add_u32 m0, s97, 49152
    s_nop 0
    buffer_load_dwordx4 v12, s[40:43], s96 offen lds
    s_add_u32 s96, s15, 4
    s_add_u32 s96, s96, s15
    s_cmp_ge_u32 s96, 6
    s_cselect_b32 s97, 6, 0
    s_sub_u32 s96, s96, s97
    s_cmp_ge_u32 s96, 6
    s_cselect_b32 s97, 6, 0
    s_sub_u32 s96, s96, s97
    s_lshl_b32 s97, s96, 13
    s_add_u32 s97, s97, s82
    s_lshl_b32 s96, s96, 16
    s_add_u32 s96, s96, s8
    s_add_u32 s96, s96, 327680
    s_add_u32 m0, s97, 49152
    s_nop 0
    buffer_load_dwordx4 v12, s[40:43], s96 offen lds
    s_add_u32 s96, s15, 5
    s_add_u32 s96, s96, s15
    s_cmp_ge_u32 s96, 6
    s_cselect_b32 s97, 6, 0
    s_sub_u32 s96, s96, s97
    s_cmp_ge_u32 s96, 6
    s_cselect_b32 s97, 6, 0
    s_sub_u32 s96, s96, s97
    s_lshl_b32 s97, s96, 13
    s_add_u32 s97, s97, s82
    s_lshl_b32 s96, s96, 16
    s_add_u32 s96, s96, s8
    s_add_u32 s96, s96, 327680
    s_add_u32 m0, s97, 49152
    s_nop 0
    buffer_load_dwordx4 v12, s[40:43], s96 offen lds
    v_max_f32 v64, 0, v64
    v_max_f32 v65, 0, v65
    v_cvt_pk_bf16_f32 v80, v64, v65
    v_max_f32 v66, 0, v66
    v_max_f32 v67, 0, v67
    v_cvt_pk_bf16_f32 v81, v66, v67
    v_max_f32 v68, 0, v68
    v_max_f32 v69, 0, v69
    v_cvt_pk_bf16_f32 v82, v68, v69
    v_max_f32 v70, 0, v70
    v_max_f32 v71, 0, v71
    v_cvt_pk_bf16_f32 v83, v70, v71
    v_max_f32 v72, 0, v72
    v_max_f32 v73, 0, v73
    v_cvt_pk_bf16_f32 v84, v72, v73
    v_max_f32 v74, 0, v74
    v_max_f32 v75, 0, v75
    v_cvt_pk_bf16_f32 v85, v74, v75
    v_max_f32 v76, 0, v76
    v_max_f32 v77, 0, v77
    v_cvt_pk_bf16_f32 v86, v76, v77
    v_max_f32 v78, 0, v78
    v_max_f32 v79, 0, v79
    v_cvt_pk_bf16_f32 v87, v78, v79
    s_lshl_b32 s17, s86, 13
    s_add_u32 s91, s17, 2048
    buffer_store_dwordx4 v[80:83], v20, s[48:51], s17 offen sc1
    buffer_store_dwordx4 v[84:87], v20, s[48:51], s91 offen sc1
    s_waitcnt vmcnt(0)
    s_add_u32 s88, s14, 32
    v_mov_b32 v25, s76
    s_mov_b64 exec, 1
    s_cmp_eq_u32 s77, 1
    s_cbranch_scc0 L_sl_7
    buffer_store_dword v25, off, s[48:51], s88
    s_branch L_sd_8
L_sl_7:
    buffer_store_dword v25, off, s[48:51], s88 sc1
L_sd_8:
    s_mov_b64 exec, -1
    s_bfe_u32 s89, s72, 0x10001
    s_lshl_b32 s90, s74, 1
    s_sub_u32 s90, s89, s90
    s_lshl_b32 s90, s90, 11
    s_lshl_b32 s89, s89, 6
    v_add_u32 v10, s90, v13
    v_xor_b32 v10, s89, v10
    v_xor_b32 v11, 64, v10
    s_xor_b32 s89, s15, s74
    s_and_b32 s89, s89, 1
    s_lshl_b32 s91, s89, 19
    s_lshl_b32 s89, s89, 8
    v_add_u32 v9, s90, v19
    v_xor_b32 v9, s91, v9
    v_lshrrev_b32 v25, 3, v0
    v_cmp_eq_u32 vcc, 3, v25
    v_xor_b32 v25, s89, v9
    s_nop 0
    v_cndmask_b32 v9, v9, v25, vcc
    buffer_load_dword v24, v21, s[48:51], 0 offen sc1
    s_waitcnt vmcnt(0)
    s_mov_b32 s94, 40000
L_pf_9:
    v_cmp_ne_u32 vcc, s76, v24
    s_nop 1
    s_and_b32 s88, vcc_lo, 0x7001f
    s_cbranch_scc0 L_pfd_10
    s_sub_u32 s94, s94, 1
    s_cbranch_scc1 L_pfd_10
    buffer_load_dword v24, v21, s[48:51], 0 offen sc1
    s_waitcnt vmcnt(0)
    s_branch L_pf_9
L_pfd_10:
    s_add_u32 s80, s5, 0
    s_cmp_ge_u32 s80, 5
    s_cselect_b32 s100, 5, 0
    s_sub_u32 s80, s80, s100
    s_lshl_b32 s80, s80, 13
    s_add_u32 s80, s80, s6
    buffer_load_dwordx4 a[0:3], v9, s[48:51], s80 offen offset:0 sc1
    s_add_u32 s80, s5, 0
    s_cmp_ge_u32 s80, 5
    s_cselect_b32 s100, 5, 0
    s_sub_u32 s80, s80, s100
    s_lshl_b32 s80, s80, 13
    s_add_u32 s80, s80, s6
    buffer_load_dwordx4 a[4:7], v9, s[48:51], s80 offen offset:2048 sc1
    s_add_u32 s80, s5, 1
    s_cmp_ge_u32 s80, 5
    s_cselect_b32 s100, 5, 0
    s_sub_u32 s80, s80, s100
    s_lshl_b32 s80, s80, 13
    s_add_u32 s80, s80, s6
    buffer_load_dwordx4 a[8:11], v9, s[48:51], s80 offen offset:0 sc1
    s_add_u32 s80, s5, 1
    s_cmp_ge_u32 s80, 5
    s_cselect_b32 s100, 5, 0
    s_sub_u32 s80, s80, s100
    s_lshl_b32 s80, s80, 13
    s_add_u32 s80, s80, s6
    buffer_load_dwordx4 a[12:15], v9, s[48:51], s80 offen offset:2048 sc1
    s_add_u32 s80, s5, 2
    s_cmp_ge_u32 s80, 5
    s_cselect_b32 s100, 5, 0
    s_sub_u32 s80, s80, s100
    s_lshl_b32 s80, s80, 13
    s_add_u32 s80, s80, s6
    buffer_load_dwordx4 a[16:19], v9, s[48:51], s80 offen offset:0 sc1
    s_add_u32 s80, s5, 2
    s_cmp_ge_u32 s80, 5
    s_cselect_b32 s100, 5, 0
    s_sub_u32 s80, s80, s100
    s_lshl_b32 s80, s80, 13
    s_add_u32 s80, s80, s6
    buffer_load_dwordx4 a[20:23], v9, s[48:51], s80 offen offset:2048 sc1
    v_and_b32 v1, 31, v0
    v_lshrrev_b32 v25, 5, v0
    v_lshlrev_b32 v25, 1, v25
    v_and_b32 v26, 7, v0
    v_xor_b32 v25, v25, v26
    v_lshlrev_b32 v25, 4, v25
    v_lshl_add_u32 v1, v1, 8, v25
    s_and_b32 s92, s72, 1
    s_lshl_b32 s92, s92, 15
    s_lshr_b32 s89, s72, 1
    s_lshl_b32 s90, s89, 13
    s_add_u32 s90, s90, s92
    s_add_u32 s90, s90, 8192
    v_add_u32 v1, s90, v1
    v_xor_b32 v2, 16, v1
    v_xor_b32 v3, 64, v1
    v_xor_b32 v4, 0x50, v1
    v_lshrrev_b32 v27, 3, v0
    v_lshlrev_b32 v5, 1, v26
    v_xor_b32 v5, v5, v27
    v_lshlrev_b32 v5, 4, v5
    v_lshl_add_u32 v5, v27, 8, v5
    s_lshl_b32 s90, s89, 11
    s_add_u32 s90, s90, s92
    s_add_u32 s90, s90, 8192
    v_add_u32 v5, s90, v5
    v_xor_b32 v6, 16, v5
    s_lshl_b32 s90, s68, 8
    s_lshl_b32 s91, s15, 6
    s_add_u32 s90, s90, s91
    s_lshr_b32 s91, s92, 10
    s_add_u32 s90, s90, s91
    s_lshl_b32 s85, s90, 3
    s_add_u32 s85, s85, 17891328
    s_lshl_b32 s91, s89, 3
    s_add_u32 s90, s90, s91
    s_lshl_b32 s90, s90, 10
    s_lshl_b32 s91, s3, 7
    s_add_u32 s90, s90, s91
    v_lshlrev_b32 v26, 4, v26
    v_lshl_add_u32 v7, v27, 10, v26
    v_add_u32 v7, s90, v7
    s_lshl_b32 s90, s68, 2
    s_add_u32 s90, s90, s15
    s_lshl_b32 s90, s90, 3
    s_add_u32 s90, s90, s3
    s_lshl_b32 s90, s90, 14
    s_lshr_b32 s91, s92, 3
    s_add_u32 s90, s90, s91
    s_add_u32 s86, s90, 20971520
    s_barrier
    s_add_u32 s96, s5, 0
    s_cmp_ge_u32 s96, 5
    s_cselect_b32 s100, 5, 0
    s_sub_u32 s96, s96, s100
    s_lshl_b32 s96, s96, 13
    v_add_u32 v15, s96, v10
    v_add_u32 v16, s96, v11
    ds_read_b64_tr_b16 v[96:97], v15 offset:8192
    ds_read_b64_tr_b16 v[98:99], v15 offset:8704
    ds_read_b64_tr_b16 v[100:101], v16 offset:8192
    ds_read_b64_tr_b16 v[102:103], v16 offset:8704
    ds_read_b64_tr_b16 v[104:105], v15 offset:10240
    ds_read_b64_tr_b16 v[106:107], v15 offset:10752
    ds_read_b64_tr_b16 v[108:109], v16 offset:10240
    ds_read_b64_tr_b16 v[110:111], v16 offset:10752
    s_add_u32 s80, s5, 3
    s_cmp_ge_u32 s80, 5
    s_cselect_b32 s100, 5, 0
    s_sub_u32 s80, s80, s100
    s_lshl_b32 s80, s80, 13
    s_add_u32 s80, s80, s6
    buffer_load_dwordx4 a[24:27], v9, s[48:51], s80 offen offset:0 sc1
    s_add_u32 s96, s5, 1
    s_cmp_ge_u32 s96, 5
    s_cselect_b32 s100, 5, 0
    s_sub_u32 s96, s96, s100
    s_lshl_b32 s96, s96, 13
    v_add_u32 v15, s96, v10
    v_add_u32 v16, s96, v11
    ds_read_b64_tr_b16 a[120:121], v15 offset:8192
    ds_read_b64_tr_b16 a[122:123], v15 offset:8704
    ds_read_b64_tr_b16 a[124:125], v16 offset:8192
    ds_read_b64_tr_b16 a[126:127], v16 offset:8704
    s_waitcnt vmcnt(6) lgkmcnt(8)
    v_mfma_f32_32x32x16_bf16 v[64:79], v[96:99], a[0:3], 0
    v_mfma_f32_32x32x16_bf16 v[80:95], v[100:103], a[0:3], 0
    s_add_u32 s80, s5, 3
    s_cmp_ge_u32 s80, 5
    s_cselect_b32 s100, 5, 0
    s_sub_u32 s80, s80, s100
    s_lshl_b32 s80, s80, 13
    s_add_u32 s80, s80, s6
    buffer_load_dwordx4 a[28:31], v9, s[48:51], s80 offen offset:2048 sc1
    ds_read_b64_tr_b16 v[96:97], v15 offset:10240
    ds_read_b64_tr_b16 v[98:99], v15 offset:10752
    ds_read_b64_tr_b16 v[100:101], v16 offset:10240
    ds_read_b64_tr_b16 v[102:103], v16 offset:10752
    s_waitcnt vmcnt(6) lgkmcnt(8)
    v_mfma_f32_32x32x16_bf16 v[64:79], v[104:107], a[4:7], v[64:79]
    v_mfma_f32_32x32x16_bf16 v[80:95], v[108:111], a[4:7], v[80:95]
    s_add_u32 s80, s5, 4
    s_cmp_ge_u32 s80, 5
    s_cselect_b32 s100, 5, 0
    s_sub_u32 s80, s80, s100
    s_lshl_b32 s80, s80, 13
    s_add_u32 s80, s80, s6
    buffer_load_dwordx4 a[32:35], v9, s[48:51], s80 offen offset:0 sc1
    s_add_u32 s96, s5, 2
    s_cmp_ge_u32 s96, 5
    s_cselect_b32 s100, 5, 0
    s_sub_u32 s96, s96, s100
    s_lshl_b32 s96, s96, 13
    v_add_u32 v15, s96, v10
    v_add_u32 v16, s96, v11
    ds_read_b64_tr_b16 v[104:105], v15 offset:8192
    ds_read_b64_tr_b16 v[106:107], v15 offset:8704
    ds_read_b64_tr_b16 v[108:109], v16 offset:8192
    ds_read_b64_tr_b16 v[110:111], v16 offset:8704
    s_waitcnt vmcnt(6) lgkmcnt(8)
    v_mfma_f32_32x32x16_bf16 v[64:79], a[120:123], a[8:11], v[64:79]
    v_mfma_f32_32x32x16_bf16 v[80:95], a[124:127], a[8:11], v[80:95]
    s_add_u32 s80, s5, 4
    s_cmp_ge_u32 s80, 5
    s_cselect_b32 s100, 5, 0
    s_sub_u32 s80, s80, s100
    s_lshl_b32 s80, s80, 13
    s_add_u32 s80, s80, s6
    buffer_load_dwordx4 a[36:39], v9, s[48:51], s80 offen offset:2048 sc1
    ds_read_b64_tr_b16 a[120:121], v15 offset:10240
    ds_read_b64_tr_b16 a[122:123], v15 offset:10752
    ds_read_b64_tr_b16 a[124:125], v16 offset:10240
    ds_read_b64_tr_b16 a[126:127], v16 offset:10752
    s_waitcnt vmcnt(6) lgkmcnt(8)
    v_mfma_f32_32x32x16_bf16 v[64:79], v[96:99], a[12:15], v[64:79]
    v_mfma_f32_32x32x16_bf16 v[80:95], v[100:103], a[12:15], v[80:95]
    s_add_u32 s80, s5, 0
    s_cmp_ge_u32 s80, 5
    s_cselect_b32 s100, 5, 0
    s_sub_u32 s80, s80, s100
    s_lshl_b32 s80, s80, 13
    s_add_u32 s80, s80, s7
    buffer_load_dwordx4 a[40:43], v19, s[48:51], s80 offen offset:0 sc1
    s_add_u32 s96, s5, 3
    s_cmp_ge_u32 s96, 5
    s_cselect_b32 s100, 5, 0
    s_sub_u32 s96, s96, s100
    s_lshl_b32 s96, s96, 13
    v_add_u32 v15, s96, v10
    v_add_u32 v16, s96, v11
    ds_read_b64_tr_b16 v[96:97], v15 offset:8192
    ds_read_b64_tr_b16 v[98:99], v15 offset:8704
    ds_read_b64_tr_b16 v[100:101], v16 offset:8192
    ds_read_b64_tr_b16 v[102:103], v16 offset:8704
    s_waitcnt vmcnt(6) lgkmcnt(8)
    v_mfma_f32_32x32x16_bf16 v[64:79], v[104:107], a[16:19], v[64:79]
    v_mfma_f32_32x32x16_bf16 v[80:95], v[108:111], a[16:19], v[80:95]
    s_add_u32 s80, s5, 1
    s_cmp_ge_u32 s80, 5
    s_cselect_b32 s100, 5, 0
    s_sub_u32 s80, s80, s100
    s_lshl_b32 s80, s80, 13
    s_add_u32 s80, s80, s7
    buffer_load_dwordx4 a[44:47], v19, s[48:51], s80 offen offset:0 sc1
    ds_read_b64_tr_b16 v[104:105], v15 offset:10240
    ds_read_b64_tr_b16 v[106:107], v15 offset:10752
    ds_read_b64_tr_b16 v[108:109], v16 offset:10240
    ds_read_b64_tr_b16 v[110:111], v16 offset:10752
    s_waitcnt vmcnt(6) lgkmcnt(8)
    v_mfma_f32_32x32x16_bf16 v[64:79], a[120:123], a[20:23], v[64:79]
    v_mfma_f32_32x32x16_bf16 v[80:95], a[124:127], a[20:23], v[80:95]
    s_mov_b32 s80, 5
    s_lshl_b32 s80, s80, 13
    s_add_u32 s80, s80, s6
    buffer_load_dwordx4 a[48:51], v9, s[48:51], s80 offen offset:0 sc1
    s_add_u32 s96, s5, 4
    s_cmp_ge_u32 s96, 5
    s_cselect_b32 s100, 5, 0
    s_sub_u32 s96, s96, s100
    s_lshl_b32 s96, s96, 13
    v_add_u32 v15, s96, v10
    v_add_u32 v16, s96, v11
    ds_read_b64_tr_b16 a[120:121], v15 offset:8192
    ds_read_b64_tr_b16 a[122:123], v15 offset:8704
    ds_read_b64_tr_b16 a[124:125], v16 offset:8192
    ds_read_b64_tr_b16 a[126:127], v16 offset:8704
    s_waitcnt vmcnt(6) lgkmcnt(8)
    v_mfma_f32_32x32x16_bf16 v[64:79], v[96:99], a[24:27], v[64:79]
    v_mfma_f32_32x32x16_bf16 v[80:95], v[100:103], a[24:27], v[80:95]
    buffer_load_dword v24, v21, s[48:51], 0 offen sc1
    s_mov_b32 s80, 5
    s_lshl_b32 s80, s80, 13
    s_add_u32 s80, s80, s6
    buffer_load_dwordx4 a[52:55], v9, s[48:51], s80 offen offset:2048 sc1
    ds_read_b64_tr_b16 v[96:97], v15 offset:10240
    ds_read_b64_tr_b16 v[98:99], v15 offset:10752
    ds_read_b64_tr_b16 v[100:101], v16 offset:10240
    ds_read_b64_tr_b16 v[102:103], v16 offset:10752
    s_waitcnt vmcnt(7) lgkmcnt(8)
    v_mfma_f32_32x32x16_bf16 v[64:79], v[104:107], a[28:31], v[64:79]
    v_mfma_f32_32x32x16_bf16 v[80:95], v[108:111], a[28:31], v[80:95]
    s_add_u32 s96, s5, 0
    s_cmp_ge_u32 s96, 5
    s_cselect_b32 s100, 5, 0
    s_sub_u32 s96, s96, s100
    s_lshl_b32 s96, s96, 13
    v_add_u32 v15, s96, v13
    v_add_u32 v16, s96, v14
    ds_read_b64_tr_b16 v[104:105], v15 offset:8192
    ds_read_b64_tr_b16 v[106:107], v15 offset:8704
    ds_read_b64_tr_b16 v[108:109], v16 offset:8192
    ds_read_b64_tr_b16 v[110:111], v16 offset:8704
    s_waitcnt vmcnt(6) lgkmcnt(8)
    v_mfma_f32_32x32x16_bf16 v[64:79], a[120:123], a[32:35], v[64:79]
    v_mfma_f32_32x32x16_bf16 v[80:95], a[124:127], a[32:35], v[80:95]
    s_add_u32 s96, s5, 1
    s_cmp_ge_u32 s96, 5
    s_cselect_b32 s100, 5, 0
    s_sub_u32 s96, s96, s100
    s_lshl_b32 s96, s96, 13
    v_add_u32 v15, s96, v13
    v_add_u32 v16, s96, v14
    ds_read_b64_tr_b16 a[120:121], v15 offset:8192
    ds_read_b64_tr_b16 a[122:123], v15 offset:8704
    ds_read_b64_tr_b16 a[124:125], v16 offset:8192
    ds_read_b64_tr_b16 a[126:127], v16 offset:8704
    s_waitcnt vmcnt(5) lgkmcnt(8)
    v_mfma_f32_32x32x16_bf16 v[64:79], v[96:99], a[36:39], v[64:79]
    v_mfma_f32_32x32x16_bf16 v[80:95], v[100:103], a[36:39], v[80:95]
    s_waitcnt vmcnt(1)
    s_mov_b32 s94, 40000
L_pf_11:
    v_cmp_ne_u32 vcc, s76, v24
    s_nop 1
    s_and_b32 s88, vcc_lo, 0x7001000
    s_cbranch_scc0 L_pfd_12
    s_sub_u32 s94, s94, 1
    s_cbranch_scc1 L_pfd_12
    buffer_load_dword v24, v21, s[48:51], 0 offen sc1
    s_waitcnt vmcnt(0)
    s_branch L_pf_11
L_pfd_12:
    s_mov_b32 s80, 6
    s_lshl_b32 s80, s80, 13
    s_add_u32 s80, s80, s6
    buffer_load_dwordx4 a[56:59], v9, s[48:51], s80 offen offset:0 sc1
    s_mov_b32 s80, 6
    s_lshl_b32 s80, s80, 13
    s_add_u32 s80, s80, s6
    buffer_load_dwordx4 a[60:63], v9, s[48:51], s80 offen offset:2048 sc1
    s_waitcnt lgkmcnt(4)
    v_mfma_f32_32x32x16_bf16 v[32:47], v[104:107], a[40:43], 0
    v_mfma_f32_32x32x16_bf16 v[48:63], v[108:111], a[40:43], 0
    s_mov_b32 s80, 7
    s_lshl_b32 s80, s80, 13
    s_add_u32 s80, s80, s6
    buffer_load_dwordx4 a[64:67], v9, s[48:51], s80 offen offset:0 sc1
    s_mov_b32 s80, 7
    s_lshl_b32 s80, s80, 13
    s_add_u32 s80, s80, s6
    buffer_load_dwordx4 a[68:71], v9, s[48:51], s80 offen offset:2048 sc1
    s_barrier
    s_mov_b32 s96, 5
    s_lshl_b32 s96, s96, 13
    v_add_u32 v15, s96, v10
    v_add_u32 v16, s96, v11
    ds_read_b64_tr_b16 v[96:97], v15 offset:8192
    ds_read_b64_tr_b16 v[98:99], v15 offset:8704
    ds_read_b64_tr_b16 v[100:101], v16 offset:8192
    ds_read_b64_tr_b16 v[102:103], v16 offset:8704
    ds_read_b64_tr_b16 v[104:105], v15 offset:10240
    ds_read_b64_tr_b16 v[106:107], v15 offset:10752
    ds_read_b64_tr_b16 v[108:109], v16 offset:10240
    ds_read_b64_tr_b16 v[110:111], v16 offset:10752
    s_waitcnt lgkmcnt(8)
    v_mfma_f32_32x32x16_bf16 v[32:47], a[120:123], a[44:47], v[32:47]
    v_mfma_f32_32x32x16_bf16 v[48:63], a[124:127], a[44:47], v[48:63]
    s_mov_b32 s80, 8
    s_lshl_b32 s80, s80, 13
    s_add_u32 s80, s80, s6
    buffer_load_dwordx4 a[72:75], v9, s[48:51], s80 offen offset:0 sc1
    s_mov_b32 s96, 6
    s_lshl_b32 s96, s96, 13
    v_add_u32 v15, s96, v10
    v_add_u32 v16, s96, v11
    ds_read_b64_tr_b16 a[120:121], v15 offset:8192
    ds_read_b64_tr_b16 a[122:123], v15 offset:8704
    ds_read_b64_tr_b16 a[124:125], v16 offset:8192
    ds_read_b64_tr_b16 a[126:127], v16 offset:8704
    s_waitcnt lgkmcnt(8)
    v_mfma_f32_32x32x16_bf16 v[64:79], v[96:99], a[48:51], v[64:79]
    v_mfma_f32_32x32x16_bf16 v[80:95], v[100:103], a[48:51], v[80:95]
    s_add_u32 s96, s15, 0
    s_and_b32 s96, s96, 3
    s_lshl_b32 s97, s15, 1
    s_and_b32 s97, s97, 4
    s_xor_b32 s97, s97, 4
    s_add_u32 s96, s96, s97
    s_lshl_b32 s97, s96, 13
    s_add_u32 s97, s97, s82
    s_lshl_b32 s96, s96, 16
    s_add_u32 m0, s97, 98304
    s_nop 0
    buffer_load_dwordx4 v12, s[44:47], s96 offen lds
    buffer_load_dword v24, v21, s[48:51], 0 offen sc1
    s_mov_b32 s80, 8
    s_lshl_b32 s80, s80, 13
    s_add_u32 s80, s80, s6
    buffer_load_dwordx4 a[76:79], v9, s[48:51], s80 offen offset:2048 sc1
    ds_read_b64_tr_b16 v[96:97], v15 offset:10240
    ds_read_b64_tr_b16 v[98:99], v15 offset:10752
    ds_read_b64_tr_b16 v[100:101], v16 offset:10240
    ds_read_b64_tr_b16 v[102:103], v16 offset:10752
    s_waitcnt vmcnt(8) lgkmcnt(8)
    v_mfma_f32_32x32x16_bf16 v[64:79], v[104:107], a[52:55], v[64:79]
    v_mfma_f32_32x32x16_bf16 v[80:95], v[108:111], a[52:55], v[80:95]
    s_add_u32 s96, s15, 1
    s_and_b32 s96, s96, 3
    s_lshl_b32 s97, s15, 1
    s_and_b32 s97, s97, 4
    s_xor_b32 s97, s97, 4
    s_add_u32 s96, s96, s97
    s_lshl_b32 s97, s96, 13
    s_add_u32 s97, s97, s82
    s_lshl_b32 s96, s96, 16
    s_add_u32 m0, s97, 98304
    s_nop 0
    buffer_load_dwordx4 v12, s[44:47], s96 offen lds
    s_mov_b32 s96, 7
    s_lshl_b32 s96, s96, 13
    v_add_u32 v15, s96, v10
    v_add_u32 v16, s96, v11
    ds_read_b64_tr_b16 v[104:105], v15 offset:8192
    ds_read_b64_tr_b16 v[106:107], v15 offset:8704
    ds_read_b64_tr_b16 v[108:109], v16 offset:8192
    ds_read_b64_tr_b16 v[110:111], v16 offset:8704
    s_waitcnt vmcnt(8) lgkmcnt(8)
    v_mfma_f32_32x32x16_bf16 v[64:79], a[120:123], a[56:59], v[64:79]
    v_mfma_f32_32x32x16_bf16 v[80:95], a[124:127], a[56:59], v[80:95]
    s_add_u32 s96, s15, 2
    s_and_b32 s96, s96, 3
    s_lshl_b32 s97, s15, 1
    s_and_b32 s97, s97, 4
    s_xor_b32 s97, s97, 4
    s_add_u32 s96, s96, s97
    s_lshl_b32 s97, s96, 13
    s_add_u32 s97, s97, s82
    s_lshl_b32 s96, s96, 16
    s_add_u32 m0, s97, 98304
    s_nop 0
    buffer_load_dwordx4 v12, s[44:47], s96 offen lds
    ds_read_b64_tr_b16 a[120:121], v15 offset:10240
    ds_read_b64_tr_b16 a[122:123], v15 offset:10752
    ds_read_b64_tr_b16 a[124:125], v16 offset:10240
    ds_read_b64_tr_b16 a[126:127], v16 offset:10752
    s_waitcnt vmcnt(8) lgkmcnt(8)
    v_mfma_f32_32x32x16_bf16 v[64:79], v[96:99], a[60:63], v[64:79]
    v_mfma_f32_32x32x16_bf16 v[80:95], v[100:103], a[60:63], v[80:95]
    s_add_u32 s96, s15, 3
    s_and_b32 s96, s96, 3
    s_lshl_b32 s97, s15, 1
    s_and_b32 s97, s97, 4
    s_xor_b32 s97, s97, 4
    s_add_u32 s96, s96, s97
    s_lshl_b32 s97, s96, 13
    s_add_u32 s97, s97, s82
    s_lshl_b32 s96, s96, 16
    s_add_u32 m0, s97, 98304
    s_nop 0
    buffer_load_dwordx4 v12, s[44:47], s96 offen lds
    s_waitcnt vmcnt(4)
    s_mov_b32 s94, 40000
L_pf_13:
    v_cmp_ne_u32 vcc, s76, v24
    s_nop 1
    s_and_b32 s88, vcc_lo, 0x30000000
    s_cbranch_scc0 L_pfd_14
    s_sub_u32 s94, s94, 1
    s_cbranch_scc1 L_pfd_14
    buffer_load_dword v24, v21, s[48:51], 0 offen sc1
    s_waitcnt vmcnt(0)
    s_branch L_pf_13
L_pfd_14:
    s_mov_b32 s80, 9
    s_lshl_b32 s80, s80, 13
    s_add_u32 s80, s80, s6
    buffer_load_dwordx4 a[80:83], v9, s[48:51], s80 offen offset:0 sc1
    s_mov_b32 s80, 9
    s_lshl_b32 s80, s80, 13
    s_add_u32 s80, s80, s6
    buffer_load_dwordx4 a[84:87], v9, s[48:51], s80 offen offset:2048 sc1
    s_mov_b32 s96, 8
    s_lshl_b32 s96, s96, 13
    v_add_u32 v15, s96, v10
    v_add_u32 v16, s96, v11
    ds_read_b64_tr_b16 v[96:97], v15 offset:8192
    ds_read_b64_tr_b16 v[98:99], v15 offset:8704
    ds_read_b64_tr_b16 v[100:101], v16 offset:8192
    ds_read_b64_tr_b16 v[102:103], v16 offset:8704
    s_waitcnt lgkmcnt(8)
    v_mfma_f32_32x32x16_bf16 v[64:79], v[104:107], a[64:67], v[64:79]
    v_mfma_f32_32x32x16_bf16 v[80:95], v[108:111], a[64:67], v[80:95]
    s_mov_b32 s80, 10
    s_lshl_b32 s80, s80, 13
    s_add_u32 s80, s80, s6
    s_lshr_b32 s100, s72, 1
    s_and_b32 s100, s100, s16
    s_cselect_b32 s80, 0x40000000, s80
    buffer_load_dwordx4 a[88:91], v9, s[48:51], s80 offen offset:0 sc1
    s_mov_b32 s80, 10
    s_lshl_b32 s80, s80, 13
    s_add_u32 s80, s80, s6
    s_lshr_b32 s100, s72, 1
    s_and_b32 s100, s100, s16
    s_cselect_b32 s80, 0x40000000, s80
    buffer_load_dwordx4 a[92:95], v9, s[48:51], s80 offen offset:2048 sc1
    ds_read_b64_tr_b16 v[104:105], v15 offset:10240
    ds_read_b64_tr_b16 v[106:107], v15 offset:10752
    ds_read_b64_tr_b16 v[108:109], v16 offset:10240
    ds_read_b64_tr_b16 v[110:111], v16 offset:10752
    s_waitcnt lgkmcnt(8)
    v_mfma_f32_32x32x16_bf16 v[64:79], a[120:123], a[68:71], v[64:79]
    v_mfma_f32_32x32x16_bf16 v[80:95], a[124:127], a[68:71], v[80:95]
    s_add_u32 s80, s5, 2
    s_cmp_ge_u32 s80, 5
    s_cselect_b32 s100, 5, 0
    s_sub_u32 s80, s80, s100
    s_lshl_b32 s80, s80, 13
    s_add_u32 s80, s80, s7
    buffer_load_dwordx4 a[96:99], v19, s[48:51], s80 offen offset:0 sc1
    s_mov_b32 s96, 9
    s_lshl_b32 s96, s96, 13
    v_add_u32 v15, s96, v10
    v_add_u32 v16, s96, v11
    ds_read_b64_tr_b16 a[120:121], v15 offset:8192
    ds_read_b64_tr_b16 a[122:123], v15 offset:8704
    ds_read_b64_tr_b16 a[124:125], v16 offset:8192
    ds_read_b64_tr_b16 a[126:127], v16 offset:8704
    s_waitcnt lgkmcnt(8)
    v_mfma_f32_32x32x16_bf16 v[64:79], v[96:99], a[72:75], v[64:79]
    v_mfma_f32_32x32x16_bf16 v[80:95], v[100:103], a[72:75], v[80:95]
    s_add_u32 s80, s5, 3
    s_cmp_ge_u32 s80, 5
    s_cselect_b32 s100, 5, 0
    s_sub_u32 s80, s80, s100
    s_lshl_b32 s80, s80, 13
    s_add_u32 s80, s80, s7
    buffer_load_dwordx4 a[100:103], v19, s[48:51], s80 offen offset:0 sc1
    ds_read_b64_tr_b16 v[96:97], v15 offset:10240
    ds_read_b64_tr_b16 v[98:99], v15 offset:10752
    ds_read_b64_tr_b16 v[100:101], v16 offset:10240
    ds_read_b64_tr_b16 v[102:103], v16 offset:10752
    s_waitcnt vmcnt(9) lgkmcnt(8)
    v_mfma_f32_32x32x16_bf16 v[64:79], v[104:107], a[76:79], v[64:79]
    v_mfma_f32_32x32x16_bf16 v[80:95], v[108:111], a[76:79], v[80:95]
    s_add_u32 s80, s5, 4
    s_cmp_ge_u32 s80, 5
    s_cselect_b32 s100, 5, 0
    s_sub_u32 s80, s80, s100
    s_lshl_b32 s80, s80, 13
    s_add_u32 s80, s80, s7
    buffer_load_dwordx4 a[104:107], v19, s[48:51], s80 offen offset:0 sc1
    s_mov_b32 s96, 10
    s_lshl_b32 s96, s96, 13
    v_add_u32 v15, s96, v10
    v_add_u32 v16, s96, v11
    ds_read_b64_tr_b16 v[104:105], v15 offset:8192
    ds_read_b64_tr_b16 v[106:107], v15 offset:8704
    ds_read_b64_tr_b16 v[108:109], v16 offset:8192
    ds_read_b64_tr_b16 v[110:111], v16 offset:8704
    s_waitcnt vmcnt(6) lgkmcnt(8)
    v_mfma_f32_32x32x16_bf16 v[64:79], a[120:123], a[80:83], v[64:79]
    v_mfma_f32_32x32x16_bf16 v[80:95], a[124:127], a[80:83], v[80:95]
    s_add_u32 s80, s5, 5
    s_cmp_ge_u32 s80, 10
    s_cselect_b32 s100, 5, 0
    s_sub_u32 s80, s80, s100
    s_lshl_b32 s80, s80, 13
    s_add_u32 s80, s80, s7
    buffer_load_dwordx4 a[108:111], v19, s[48:51], s80 offen offset:0 sc1
    ds_read_b64_tr_b16 a[120:121], v15 offset:10240
    ds_read_b64_tr_b16 a[122:123], v15 offset:10752
    ds_read_b64_tr_b16 a[124:125], v16 offset:10240
    ds_read_b64_tr_b16 a[126:127], v16 offset:10752
    s_waitcnt vmcnt(6) lgkmcnt(8)
    v_mfma_f32_32x32x16_bf16 v[64:79], v[96:99], a[84:87], v[64:79]
    v_mfma_f32_32x32x16_bf16 v[80:95], v[100:103], a[84:87], v[80:95]
    s_add_u32 s80, s5, 6
    s_cmp_ge_u32 s80, 10
    s_cselect_b32 s100, 5, 0
    s_sub_u32 s80, s80, s100
    s_lshl_b32 s80, s80, 13
    s_add_u32 s80, s80, s7
    buffer_load_dwordx4 a[112:115], v19, s[48:51], s80 offen offset:0 sc1
    s_add_u32 s96, s5, 2
    s_cmp_ge_u32 s96, 5
    s_cselect_b32 s100, 5, 0
    s_sub_u32 s96, s96, s100
    s_lshl_b32 s96, s96, 13
    v_add_u32 v15, s96, v13
    v_add_u32 v16, s96, v14
    ds_read_b64_tr_b16 v[96:97], v15 offset:8192
    ds_read_b64_tr_b16 v[98:99], v15 offset:8704
    ds_read_b64_tr_b16 v[100:101], v16 offset:8192
    ds_read_b64_tr_b16 v[102:103], v16 offset:8704
    s_waitcnt vmcnt(6) lgkmcnt(8)
    v_mfma_f32_32x32x16_bf16 v[64:79], v[104:107], a[88:91], v[64:79]
    v_mfma_f32_32x32x16_bf16 v[80:95], v[108:111], a[88:91], v[80:95]
    s_add_u32 s80, s5, 7
    s_cmp_ge_u32 s80, 10
    s_cselect_b32 s100, 5, 0
    s_sub_u32 s80, s80, s100
    s_lshl_b32 s80, s80, 13
    s_add_u32 s80, s80, s7
    buffer_load_dwordx4 a[116:119], v19, s[48:51], s80 offen offset:0 sc1
    s_add_u32 s96, s5, 3
    s_cmp_ge_u32 s96, 5
    s_cselect_b32 s100, 5, 0
    s_sub_u32 s96, s96, s100
    s_lshl_b32 s96, s96, 13
    v_add_u32 v15, s96, v13
    v_add_u32 v16, s96, v14
    ds_read_b64_tr_b16 v[104:105], v15 offset:8192
    ds_read_b64_tr_b16 v[106:107], v15 offset:8704
    ds_read_b64_tr_b16 v[108:109], v16 offset:8192
    ds_read_b64_tr_b16 v[110:111], v16 offset:8704
    s_waitcnt vmcnt(6) lgkmcnt(8)
    v_mfma_f32_32x32x16_bf16 v[64:79], a[120:123], a[92:95], v[64:79]
    v_mfma_f32_32x32x16_bf16 v[80:95], a[124:127], a[92:95], v[80:95]
    s_add_u32 s80, s5, 8
    s_cmp_ge_u32 s80, 10
    s_cselect_b32 s100, 5, 0
    s_sub_u32 s80, s80, s100
    s_lshl_b32 s80, s80, 13
    s_add_u32 s80, s80, s7
    buffer_load_dwordx4 a[0:3], v19, s[48:51], s80 offen offset:0 sc1
    s_add_u32 s80, s5, 9
    s_cmp_ge_u32 s80, 10
    s_cselect_b32 s100, 5, 0
    s_sub_u32 s80, s80, s100
    s_lshl_b32 s80, s80, 13
    s_add_u32 s80, s80, s7
    buffer_load_dwordx4 a[4:7], v19, s[48:51], s80 offen offset:0 sc1
    s_mov_b32 s80, 10
    s_lshl_b32 s80, s80, 13
    s_add_u32 s80, s80, s7
    s_and_b32 s100, s16, s74
    s_cselect_b32 s80, 0x40000000, s80
    buffer_load_dwordx4 a[8:11], v19, s[48:51], s80 offen offset:0 sc1
    s_waitcnt lgkmcnt(0)
    s_lshl_b32 s88, s72, 12
    s_and_b32 s89, s15, 2
    s_lshl_b32 s89, s89, 14
    s_add_u32 s88, s88, s89
    s_add_u32 s89, s88, 98304
    s_xor_b32 s88, s88, 0x2000
    s_add_u32 s88, s88, 98304
    v_add_u32 v25, s89, v22
    v_add_u32 v26, s88, v22
    ds_write_b128 v25, v[80:83] offset:0
    ds_write_b128 v25, v[84:87] offset:1024
    ds_write_b128 v25, v[88:91] offset:2048
    ds_write_b128 v25, v[92:95] offset:3072
    s_xor_b32 s89, s15, s74
    s_and_b32 s89, s89, 1
    s_lshl_b32 s89, s89, 17
    s_xor_b32 s90, s86, s89
    s_bfe_u32 s89, s72, 0x10001
    s_lshl_b32 s89, s89, 11
    s_add_u32 s90, s90, s89
    s_waitcnt lgkmcnt(0)
    s_barrier
    ds_read_b128 v[80:83], v26 offset:0
    ds_read_b128 v[84:87], v26 offset:1024
    ds_read_b128 v[88:91], v26 offset:2048
    ds_read_b128 v[92:95], v26 offset:3072
    s_waitcnt lgkmcnt(2)
    v_add_f32 v64, v64, v80
    v_add_f32 v65, v65, v81
    v_add_f32 v66, v66, v82
    v_add_f32 v67, v67, v83
    v_add_f32 v68, v68, v84
    v_add_f32 v69, v69, v85
    v_add_f32 v70, v70, v86
    v_add_f32 v71, v71, v87
    v_cvt_pk_bf16_f32 v64, v64, v65
    v_cvt_pk_bf16_f32 v65, v66, v67
    v_cvt_pk_bf16_f32 v66, v68, v69
    v_cvt_pk_bf16_f32 v67, v70, v71
    buffer_store_dwordx4 v[64:67], v22, s[48:51], s90 offen offset:0 sc1
    s_waitcnt lgkmcnt(0)
    v_add_f32 v72, v72, v88
    v_add_f32 v73, v73, v89
    v_add_f32 v74, v74, v90
    v_add_f32 v75, v75, v91
    v_add_f32 v76, v76, v92
    v_add_f32 v77, v77, v93
    v_add_f32 v78, v78, v94
    v_add_f32 v79, v79, v95
    v_cvt_pk_bf16_f32 v72, v72, v73
    v_cvt_pk_bf16_f32 v73, v74, v75
    v_cvt_pk_bf16_f32 v74, v76, v77
    v_cvt_pk_bf16_f32 v75, v78, v79
    buffer_store_dwordx4 v[72:75], v22, s[48:51], s90 offen offset:1024 sc1
    s_barrier
    s_add_u32 s96, s5, 4
    s_cmp_ge_u32 s96, 5
    s_cselect_b32 s100, 5, 0
    s_sub_u32 s96, s96, s100
    s_lshl_b32 s96, s96, 13
    v_add_u32 v15, s96, v13
    v_add_u32 v16, s96, v14
    ds_read_b64_tr_b16 a[120:121], v15 offset:8192
    ds_read_b64_tr_b16 a[122:123], v15 offset:8704
    ds_read_b64_tr_b16 a[124:125], v16 offset:8192
    ds_read_b64_tr_b16 a[126:127], v16 offset:8704
    s_waitcnt vmcnt(10)
    v_mfma_f32_32x32x16_bf16 v[32:47], v[96:99], a[96:99], v[32:47]
    v_mfma_f32_32x32x16_bf16 v[48:63], v[100:103], a[96:99], v[48:63]
    s_add_u32 s96, s15, 0
    s_and_b32 s96, s96, 3
    s_lshl_b32 s97, s15, 1
    s_and_b32 s97, s97, 4
    s_xor_b32 s97, s97, 0
    s_add_u32 s96, s96, s97
    s_lshl_b32 s97, s96, 13
    s_add_u32 s97, s97, s82
    s_lshl_b32 s96, s96, 16
    s_add_u32 m0, s97, 98304
    s_nop 0
    buffer_load_dwordx4 v12, s[44:47], s96 offen lds
    s_add_u32 s96, s5, 5
    s_cmp_ge_u32 s96, 10
    s_cselect_b32 s100, 5, 0
    s_sub_u32 s96, s96, s100
    s_lshl_b32 s96, s96, 13
    v_add_u32 v15, s96, v13
    v_add_u32 v16, s96, v14
    ds_read_b64_tr_b16 v[96:97], v15 offset:8192
    ds_read_b64_tr_b16 v[98:99], v15 offset:8704
    ds_read_b64_tr_b16 v[100:101], v16 offset:8192
    ds_read_b64_tr_b16 v[102:103], v16 offset:8704
    s_waitcnt vmcnt(10)
    v_mfma_f32_32x32x16_bf16 v[32:47], v[104:107], a[100:103], v[32:47]
    v_mfma_f32_32x32x16_bf16 v[48:63], v[108:111], a[100:103], v[48:63]
    s_add_u32 s96, s15, 1
    s_and_b32 s96, s96, 3
    s_lshl_b32 s97, s15, 1
    s_and_b32 s97, s97, 4
    s_xor_b32 s97, s97, 0
    s_add_u32 s96, s96, s97
    s_lshl_b32 s97, s96, 13
    s_add_u32 s97, s97, s82
    s_lshl_b32 s96, s96, 16
    s_add_u32 m0, s97, 98304
    s_nop 0
    buffer_load_dwordx4 v12, s[44:47], s96 offen lds
    s_add_u32 s96, s5, 6
    s_cmp_ge_u32 s96, 10
    s_cselect_b32 s100, 5, 0
    s_sub_u32 s96, s96, s100
    s_lshl_b32 s96, s96, 13
    v_add_u32 v15, s96, v13
    v_add_u32 v16, s96, v14
    ds_read_b64_tr_b16 v[104:105], v15 offset:8192
    ds_read_b64_tr_b16 v[106:107], v15 offset:8704
    ds_read_b64_tr_b16 v[108:109], v16 offset:8192
    ds_read_b64_tr_b16 v[110:111], v16 offset:8704
    s_waitcnt vmcnt(10) lgkmcnt(8)
    v_mfma_f32_32x32x16_bf16 v[32:47], a[120:123], a[104:107], v[32:47]
    v_mfma_f32_32x32x16_bf16 v[48:63], a[124:127], a[104:107], v[48:63]
    s_add_u32 s96, s15, 2
    s_and_b32 s96, s96, 3
    s_lshl_b32 s97, s15, 1
    s_and_b32 s97, s97, 4
    s_xor_b32 s97, s97, 0
    s_add_u32 s96, s96, s97
    s_lshl_b32 s97, s96, 13
    s_add_u32 s97, s97, s82
    s_lshl_b32 s96, s96, 16
    s_add_u32 m0, s97, 98304
    s_nop 0
    buffer_load_dwordx4 v12, s[44:47], s96 offen lds
    s_add_u32 s96, s5, 7
    s_cmp_ge_u32 s96, 10
    s_cselect_b32 s100, 5, 0
    s_sub_u32 s96, s96, s100
    s_lshl_b32 s96, s96, 13
    v_add_u32 v15, s96, v13
    v_add_u32 v16, s96, v14
    ds_read_b64_tr_b16 a[120:121], v15 offset:8192
    ds_read_b64_tr_b16 a[122:123], v15 offset:8704
    ds_read_b64_tr_b16 a[124:125], v16 offset:8192
    ds_read_b64_tr_b16 a[126:127], v16 offset:8704
    s_waitcnt vmcnt(10) lgkmcnt(8)
    v_mfma_f32_32x32x16_bf16 v[32:47], v[96:99], a[108:111], v[32:47]
    v_mfma_f32_32x32x16_bf16 v[48:63], v[100:103], a[108:111], v[48:63]
    s_add_u32 s96, s15, 3
    s_and_b32 s96, s96, 3
    s_lshl_b32 s97, s15, 1
    s_and_b32 s97, s97, 4
    s_xor_b32 s97, s97, 0
    s_add_u32 s96, s96, s97
    s_lshl_b32 s97, s96, 13
    s_add_u32 s97, s97, s82
    s_lshl_b32 s96, s96, 16
    s_add_u32 m0, s97, 98304
    s_nop 0
    buffer_load_dwordx4 v12, s[44:47], s96 offen lds
    s_add_u32 s96, s5, 8
    s_cmp_ge_u32 s96, 10
    s_cselect_b32 s100, 5, 0
    s_sub_u32 s96, s96, s100
    s_lshl_b32 s96, s96, 13
    v_add_u32 v15, s96, v13
    v_add_u32 v16, s96, v14
    ds_read_b64_tr_b16 v[96:97], v15 offset:8192
    ds_read_b64_tr_b16 v[98:99], v15 offset:8704
    ds_read_b64_tr_b16 v[100:101], v16 offset:8192
    ds_read_b64_tr_b16 v[102:103], v16 offset:8704
    s_waitcnt vmcnt(10) lgkmcnt(8)
    v_mfma_f32_32x32x16_bf16 v[32:47], v[104:107], a[112:115], v[32:47]
    v_mfma_f32_32x32x16_bf16 v[48:63], v[108:111], a[112:115], v[48:63]
    s_add_u32 s96, s5, 9
    s_cmp_ge_u32 s96, 10
    s_cselect_b32 s100, 5, 0
    s_sub_u32 s96, s96, s100
    s_lshl_b32 s96, s96, 13
    v_add_u32 v15, s96, v13
    v_add_u32 v16, s96, v14
    ds_read_b64_tr_b16 v[104:105], v15 offset:8192
    ds_read_b64_tr_b16 v[106:107], v15 offset:8704
    ds_read_b64_tr_b16 v[108:109], v16 offset:8192
    ds_read_b64_tr_b16 v[110:111], v16 offset:8704
    s_waitcnt vmcnt(9) lgkmcnt(8)
    v_mfma_f32_32x32x16_bf16 v[32:47], a[120:123], a[116:119], v[32:47]
    v_mfma_f32_32x32x16_bf16 v[48:63], a[124:127], a[116:119], v[48:63]
    s_mov_b32 s96, 10
    s_lshl_b32 s96, s96, 13
    v_add_u32 v15, s96, v13
    v_add_u32 v16, s96, v14
    ds_read_b64_tr_b16 a[120:121], v15 offset:8192
    ds_read_b64_tr_b16 a[122:123], v15 offset:8704
    ds_read_b64_tr_b16 a[124:125], v16 offset:8192
    ds_read_b64_tr_b16 a[126:127], v16 offset:8704
    s_waitcnt vmcnt(8) lgkmcnt(8)
    v_mfma_f32_32x32x16_bf16 v[32:47], v[96:99], a[0:3], v[32:47]
    v_mfma_f32_32x32x16_bf16 v[48:63], v[100:103], a[0:3], v[48:63]
    v_and_b32 v26, 31, v0
    v_lshlrev_b32 v26, 3, v26
    v_and_b32 v28, 0x38, v0
    s_lshr_b32 s89, s72, 1
    s_lshl_b32 s89, s89, 6
    s_add_u32 s89, s89, s85
    buffer_load_dwordx2 v[26:27], v26, s[48:51], s85 offen sc1
    buffer_load_dwordx2 v[28:29], v28, s[48:51], s89 offen sc1
    buffer_load_dword v24, v21, s[48:51], 0 offen sc1
    s_waitcnt vmcnt(10) lgkmcnt(4)
    v_mfma_f32_32x32x16_bf16 v[32:47], v[104:107], a[4:7], v[32:47]
    v_mfma_f32_32x32x16_bf16 v[48:63], v[108:111], a[4:7], v[48:63]
    s_waitcnt vmcnt(9) lgkmcnt(0)
    v_mfma_f32_32x32x16_bf16 v[32:47], a[120:123], a[8:11], v[32:47]
    v_mfma_f32_32x32x16_bf16 v[48:63], a[124:127], a[8:11], v[48:63]
    s_and_b32 s88, s15, 2
    s_add_u32 s88, s88, s74
    s_lshl_b32 s89, s68, 2
    s_add_u32 s88, s88, s89
    s_lshl_b32 s88, s88, 3
    s_add_u32 s88, s88, s3
    s_lshl_b32 s88, s88, 1
    s_and_b32 s89, s72, 1
    s_add_u32 s88, s88, s89
    s_lshl_b32 s88, s88, 6
    s_and_b32 s89, s72, 2
    s_lshl_b32 s89, s89, 1
    s_add_u32 s88, s88, s89
    s_add_u32 s88, s88, 18219008
    v_mov_b32 v25, s76
    s_waitcnt vmcnt(7)
    s_mov_b64 exec, 1
    buffer_store_dword v25, off, s[48:51], s88 sc1
    s_mov_b64 exec, -1
    s_mov_b32 s56, s20
    s_mov_b32 s57, s21
    s_mov_b32 s58, 2097152
    s_mov_b32 s59, 0x20000
    s_waitcnt vmcnt(4)
    s_barrier
    ds_read_b64_tr_b16 v[96:97], v17 offset:0
    ds_read_b64_tr_b16 v[98:99], v17 offset:512
    ds_read_b64_tr_b16 v[100:101], v18 offset:0
    ds_read_b64_tr_b16 v[102:103], v18 offset:512
    s_waitcnt vmcnt(2)
    s_mov_b32 s94, 40000
L_sp_15:
    v_cmp_ne_u32 vcc, s76, v27
    v_cmp_ne_u32 s[98:99], s76, v29
    s_nop 1
    s_or_b64 vcc, vcc, s[98:99]
    s_cbranch_vccz L_spd_16
    s_sub_u32 s94, s94, 1
    s_cbranch_scc1 L_spd_16
    v_and_b32 v26, 31, v0
    v_lshlrev_b32 v26, 3, v26
    v_and_b32 v28, 0x38, v0
    s_lshr_b32 s89, s72, 1
    s_lshl_b32 s89, s89, 6
    s_add_u32 s89, s89, s85
    buffer_load_dwordx2 v[26:27], v26, s[48:51], s85 offen sc1
    buffer_load_dwordx2 v[28:29], v28, s[48:51], s89 offen sc1
    s_waitcnt vmcnt(0)
    s_branch L_sp_15
L_spd_16:
    s_waitcnt vmcnt(1)
    s_mov_b32 s94, 40000
L_pf_17:
    v_cmp_ne_u32 vcc, s76, v24
    s_nop 1
    s_and_b32 s88, vcc_hi, 0xff
    s_cbranch_scc0 L_pfd_18
    s_sub_u32 s94, s94, 1
    s_cbranch_scc1 L_pfd_18
    buffer_load_dword v24, v21, s[48:51], 0 offen sc1
    s_waitcnt vmcnt(0)
    s_branch L_pf_17
L_pfd_18:
    s_lshl_b32 s93, s16, 21
    s_add_u32 s93, s93, 180224
    s_add_u32 s88, s93, 0
    buffer_load_dwordx4 a[0:3], v19, s[48:51], s88 offen sc1
    v_sub_f32 v27, 1.0, v26
    v_sub_f32 v28, 1.0, v28
    v_mul_f32 v32, v27, v32
    v_mul_f32 v33, v27, v33
    v_mul_f32 v34, v27, v34
    v_mul_f32 v35, v27, v35
    v_mul_f32 v36, v27, v36
    s_add_u32 s88, s93, 8192
    buffer_load_dwordx4 a[4:7], v19, s[48:51], s88 offen sc1
    v_mul_f32 v37, v27, v37
    v_mul_f32 v38, v27, v38
    v_mul_f32 v39, v27, v39
    v_mul_f32 v40, v27, v40
    v_mul_f32 v41, v27, v41
    s_add_u32 s88, s93, 16384
    buffer_load_dwordx4 a[8:11], v19, s[48:51], s88 offen sc1
    v_mul_f32 v42, v27, v42
    v_mul_f32 v43, v27, v43
    v_mul_f32 v44, v27, v44
    v_mul_f32 v45, v27, v45
    v_mul_f32 v46, v27, v46
    v_mul_f32 v47, v27, v47
    s_add_u32 s88, s93, 24576
    buffer_load_dwordx4 a[12:15], v19, s[48:51], s88 offen sc1
    v_mul_f32 v48, v27, v48
    v_mul_f32 v49, v27, v49
    v_mul_f32 v50, v27, v50
    v_mul_f32 v51, v27, v51
    v_mul_f32 v52, v27, v52
    s_add_u32 s88, s93, 32768
    buffer_load_dwordx4 a[16:19], v19, s[48:51], s88 offen sc1
    v_mul_f32 v53, v27, v53
    v_mul_f32 v54, v27, v54
    v_mul_f32 v55, v27, v55
    v_mul_f32 v56, v27, v56
    v_mul_f32 v57, v27, v57
    s_add_u32 s88, s93, 40960
    buffer_load_dwordx4 a[20:23], v19, s[48:51], s88 offen sc1
    v_mul_f32 v58, v27, v58
    v_mul_f32 v59, v27, v59
    v_mul_f32 v60, v27, v60
    v_mul_f32 v61, v27, v61
    v_mul_f32 v62, v27, v62
    v_mul_f32 v63, v27, v63
    ds_read_b64_tr_b16 v[104:105], v17 offset:8192
    ds_read_b64_tr_b16 v[106:107], v17 offset:8704
    ds_read_b64_tr_b16 v[108:109], v18 offset:8192
    ds_read_b64_tr_b16 v[110:111], v18 offset:8704
    s_add_u32 s88, s93, 49152
    buffer_load_dwordx4 a[24:27], v19, s[48:51], s88 offen sc1
    buffer_load_dword v24, v21, s[48:51], 0 offen sc1
    s_waitcnt vmcnt(7) lgkmcnt(4)
    v_mfma_f32_32x32x16_bf16 v[64:79], v[96:99], a[0:3], 0
    v_mfma_f32_32x32x16_bf16 v[80:95], v[100:103], a[0:3], 0
    ds_read_b64_tr_b16 v[96:97], v17 offset:16384
    ds_read_b64_tr_b16 v[98:99], v17 offset:16896
    ds_read_b64_tr_b16 v[100:101], v18 offset:16384
    ds_read_b64_tr_b16 v[102:103], v18 offset:16896
    s_add_u32 s88, s93, 57344
    buffer_load_dwordx4 a[28:31], v19, s[48:51], s88 offen sc1
    s_waitcnt vmcnt(7) lgkmcnt(4)
    v_mfma_f32_32x32x16_bf16 v[64:79], v[104:107], a[4:7], v[64:79]
    v_mfma_f32_32x32x16_bf16 v[80:95], v[108:111], a[4:7], v[80:95]
    ds_read_b64_tr_b16 v[104:105], v17 offset:24576
    ds_read_b64_tr_b16 v[106:107], v17 offset:25088
    ds_read_b64_tr_b16 v[108:109], v18 offset:24576
    ds_read_b64_tr_b16 v[110:111], v18 offset:25088
    s_waitcnt vmcnt(6) lgkmcnt(4)
    v_mfma_f32_32x32x16_bf16 v[64:79], v[96:99], a[8:11], v[64:79]
    v_mfma_f32_32x32x16_bf16 v[80:95], v[100:103], a[8:11], v[80:95]
    ds_read_b64_tr_b16 v[96:97], v17 offset:32768
    ds_read_b64_tr_b16 v[98:99], v17 offset:33280
    ds_read_b64_tr_b16 v[100:101], v18 offset:32768
    ds_read_b64_tr_b16 v[102:103], v18 offset:33280
    s_waitcnt vmcnt(5) lgkmcnt(4)
    v_mfma_f32_32x32x16_bf16 v[64:79], v[104:107], a[12:15], v[64:79]
    v_mfma_f32_32x32x16_bf16 v[80:95], v[108:111], a[12:15], v[80:95]
    ds_read_b64_tr_b16 v[104:105], v17 offset:40960
    ds_read_b64_tr_b16 v[106:107], v17 offset:41472
    ds_read_b64_tr_b16 v[108:109], v18 offset:40960
    ds_read_b64_tr_b16 v[110:111], v18 offset:41472
    s_waitcnt vmcnt(1)
    s_mov_b32 s94, 40000
L_pf_19:
    v_cmp_ne_u32 vcc, s76, v24
    s_nop 1
    s_and_b32 s88, vcc_hi, 0x30000
    s_cbranch_scc0 L_pfd_20
    s_sub_u32 s94, s94, 1
    s_cbranch_scc1 L_pfd_20
    buffer_load_dword v24, v21, s[48:51], 0 offen sc1
    s_waitcnt vmcnt(0)
    s_branch L_pf_19
L_pfd_20:
    s_xor_b32 s90, s86, 524288
    s_lshr_b32 s91, s72, 1
    s_lshl_b32 s91, s91, 7
    s_add_u32 s90, s90, s91
    v_bfe_u32 v8, v0, 1, 2
    v_and_b32 v9, 1, v0
    v_lshlrev_b32 v8, 10, v8
    v_lshl_add_u32 v8, v9, 9, v8
    v_lshrrev_b32 v9, 3, v0
    v_lshl_add_u32 v8, v9, 4, v8
    buffer_load_dwordx4 v[120:123], v8, s[48:51], s90 offen sc1
    s_waitcnt lgkmcnt(4)
    v_mfma_f32_32x32x16_bf16 v[64:79], v[96:99], a[16:19], v[64:79]
    v_mfma_f32_32x32x16_bf16 v[80:95], v[100:103], a[16:19], v[80:95]
    ds_read_b64_tr_b16 v[96:97], v17 offset:49152
    ds_read_b64_tr_b16 v[98:99], v17 offset:49664
    ds_read_b64_tr_b16 v[100:101], v18 offset:49152
    ds_read_b64_tr_b16 v[102:103], v18 offset:49664
    s_waitcnt lgkmcnt(4)
    v_mfma_f32_32x32x16_bf16 v[64:79], v[104:107], a[20:23], v[64:79]
    v_mfma_f32_32x32x16_bf16 v[80:95], v[108:111], a[20:23], v[80:95]
    ds_read_b64_tr_b16 v[104:105], v17 offset:57344
    ds_read_b64_tr_b16 v[106:107], v17 offset:57856
    ds_read_b64_tr_b16 v[108:109], v18 offset:57344
    ds_read_b64_tr_b16 v[110:111], v18 offset:57856
    s_waitcnt lgkmcnt(4)
    v_mfma_f32_32x32x16_bf16 v[64:79], v[96:99], a[24:27], v[64:79]
    v_mfma_f32_32x32x16_bf16 v[80:95], v[100:103], a[24:27], v[80:95]
    s_waitcnt vmcnt(1) lgkmcnt(0)
    v_mfma_f32_32x32x16_bf16 v[64:79], v[104:107], a[28:31], v[64:79]
    v_mfma_f32_32x32x16_bf16 v[80:95], v[108:111], a[28:31], v[80:95]
    s_nop 10
    v_pk_fma_f32 v[32:33], v[64:65], v[26:27], v[32:33] op_sel_hi:[1,0,1]
    v_pk_fma_f32 v[34:35], v[66:67], v[26:27], v[34:35] op_sel_hi:[1,0,1]
    ds_write_b128 v1, v[32:35] offset:0
    v_pk_fma_f32 v[36:37], v[68:69], v[26:27], v[36:37] op_sel_hi:[1,0,1]
    v_pk_fma_f32 v[38:39], v[70:71], v[26:27], v[38:39] op_sel_hi:[1,0,1]
    ds_write_b128 v2, v[36:39] offset:0
    v_pk_fma_f32 v[40:41], v[72:73], v[26:27], v[40:41] op_sel_hi:[1,0,1]
    v_pk_fma_f32 v[42:43], v[74:75], v[26:27], v[42:43] op_sel_hi:[1,0,1]
    ds_write_b128 v3, v[40:43] offset:0
    v_pk_fma_f32 v[44:45], v[76:77], v[26:27], v[44:45] op_sel_hi:[1,0,1]
    v_pk_fma_f32 v[46:47], v[78:79], v[26:27], v[46:47] op_sel_hi:[1,0,1]
    ds_write_b128 v4, v[44:47] offset:0
    v_pk_fma_f32 v[48:49], v[80:81], v[26:27], v[48:49] op_sel_hi:[1,0,1]
    v_pk_fma_f32 v[50:51], v[82:83], v[26:27], v[50:51] op_sel_hi:[1,0,1]
    ds_write_b128 v1, v[48:51] offset:128
    v_pk_fma_f32 v[52:53], v[84:85], v[26:27], v[52:53] op_sel_hi:[1,0,1]
    v_pk_fma_f32 v[54:55], v[86:87], v[26:27], v[54:55] op_sel_hi:[1,0,1]
    ds_write_b128 v2, v[52:55] offset:128
    v_pk_fma_f32 v[56:57], v[88:89], v[26:27], v[56:57] op_sel_hi:[1,0,1]
    v_pk_fma_f32 v[58:59], v[90:91], v[26:27], v[58:59] op_sel_hi:[1,0,1]
    ds_write_b128 v3, v[56:59] offset:128
    v_pk_fma_f32 v[60:61], v[92:93], v[26:27], v[60:61] op_sel_hi:[1,0,1]
    v_pk_fma_f32 v[62:63], v[94:95], v[26:27], v[62:63] op_sel_hi:[1,0,1]
    ds_write_b128 v4, v[60:63] offset:128
    s_waitcnt vmcnt(0)
    v_lshlrev_b32 v112, 16, v120
    v_and_b32 v113, 0xffff0000, v120
    v_lshlrev_b32 v114, 16, v121
    v_and_b32 v115, 0xffff0000, v121
    v_lshlrev_b32 v116, 16, v122
    v_and_b32 v117, 0xffff0000, v122
    v_lshlrev_b32 v118, 16, v123
    v_and_b32 v119, 0xffff0000, v123
    s_waitcnt lgkmcnt(0)
    s_barrier
    ds_read_b128 v[64:67], v5 offset:0
    ds_read_b128 v[68:71], v6 offset:0
    ds_read_b128 v[72:75], v5 offset:8192
    ds_read_b128 v[76:79], v6 offset:8192
    ds_read_b128 v[80:83], v5 offset:16384
    ds_read_b128 v[84:87], v6 offset:16384
    ds_read_b128 v[88:91], v5 offset:24576
    ds_read_b128 v[92:95], v6 offset:24576
    s_waitcnt lgkmcnt(4)
    v_pk_add_f32 v[64:65], v[64:65], v[72:73]
    v_pk_add_f32 v[66:67], v[66:67], v[74:75]
    v_pk_add_f32 v[68:69], v[68:69], v[76:77]
    v_pk_add_f32 v[70:71], v[70:71], v[78:79]
    s_waitcnt lgkmcnt(0)
    v_pk_add_f32 v[80:81], v[80:81], v[88:89]
    v_pk_add_f32 v[82:83], v[82:83], v[90:91]
    v_pk_add_f32 v[84:85], v[84:85], v[92:93]
    v_pk_add_f32 v[86:87], v[86:87], v[94:95]
    v_pk_add_f32 v[64:65], v[64:65], v[80:81]
    v_pk_add_f32 v[66:67], v[66:67], v[82:83]
    v_pk_add_f32 v[68:69], v[68:69], v[84:85]
    v_pk_add_f32 v[70:71], v[70:71], v[86:87]
    v_pk_fma_f32 v[64:65], v[112:113], v[28:29], v[64:65] op_sel_hi:[1,0,1]
    v_pk_fma_f32 v[66:67], v[114:115], v[28:29], v[66:67] op_sel_hi:[1,0,1]
    v_pk_fma_f32 v[68:69], v[116:117], v[28:29], v[68:69] op_sel_hi:[1,0,1]
    v_pk_fma_f32 v[70:71], v[118:119], v[28:29], v[70:71] op_sel_hi:[1,0,1]
    v_cvt_pk_bf16_f32 v72, v64, v65
    v_cvt_pk_bf16_f32 v73, v66, v67
    v_cvt_pk_bf16_f32 v74, v68, v69
    v_cvt_pk_bf16_f32 v75, v70, v71
    buffer_store_dwordx4 v[72:75], v7, s[56:59], 0 offen nt
    s_endpgm
L_hq:
    ds_read_b64_tr_b16 v[80:81], v11 offset:32768
    ds_read_b64_tr_b16 v[82:83], v11 offset:33280
    ds_read_b64_tr_b16 v[84:85], v11 offset:34816
    ds_read_b64_tr_b16 v[86:87], v11 offset:35328
    ds_read_b64_tr_b16 v[88:89], v11 offset:36864
    ds_read_b64_tr_b16 v[90:91], v11 offset:37376
    s_waitcnt lgkmcnt(4)
    v_mfma_f32_32x32x16_bf16 v[64:79], v[80:83], a[64:67], v[64:79]
    ds_read_b64_tr_b16 v[92:93], v11 offset:38912
    ds_read_b64_tr_b16 v[94:95], v11 offset:39424
    s_waitcnt lgkmcnt(4)
    v_mfma_f32_32x32x16_bf16 v[64:79], v[84:87], a[68:71], v[64:79]
    ds_read_b64_tr_b16 v[80:81], v11 offset:40960
    ds_read_b64_tr_b16 v[82:83], v11 offset:41472
    s_add_u32 s96, s15, 2
    s_cmp_ge_u32 s96, 5
    s_cselect_b32 s97, 5, 0
    s_sub_u32 s96, s96, s97
    s_lshl_b32 s97, s96, 13
    s_add_u32 s97, s97, s82
    s_lshl_b32 s96, s96, 16
    s_add_u32 s96, s96, s8
    s_add_u32 m0, s97, 8192
    s_nop 0
    buffer_load_dwordx4 v12, s[40:43], s96 offen lds
    s_waitcnt lgkmcnt(4)
    v_mfma_f32_32x32x16_bf16 v[64:79], v[88:91], a[72:75], v[64:79]
    ds_read_b64_tr_b16 v[84:85], v11 offset:43008
    ds_read_b64_tr_b16 v[86:87], v11 offset:43520
    s_waitcnt lgkmcnt(4)
    v_mfma_f32_32x32x16_bf16 v[64:79], v[92:95], a[76:79], v[64:79]
    ds_read_b64_tr_b16 v[88:89], v11 offset:45056
    ds_read_b64_tr_b16 v[90:91], v11 offset:45568
    s_waitcnt lgkmcnt(4)
    v_mfma_f32_32x32x16_bf16 v[64:79], v[80:83], a[80:83], v[64:79]
    ds_read_b64_tr_b16 v[92:93], v11 offset:47104
    ds_read_b64_tr_b16 v[94:95], v11 offset:47616
    s_add_u32 s96, s15, 3
    s_cmp_ge_u32 s96, 5
    s_cselect_b32 s97, 5, 0
    s_sub_u32 s96, s96, s97
    s_lshl_b32 s97, s96, 13
    s_add_u32 s97, s97, s82
    s_lshl_b32 s96, s96, 16
    s_add_u32 s96, s96, s8
    s_add_u32 m0, s97, 8192
    s_nop 0
    buffer_load_dwordx4 v12, s[40:43], s96 offen lds
    s_waitcnt lgkmcnt(4)
    v_mfma_f32_32x32x16_bf16 v[64:79], v[84:87], a[84:87], v[64:79]
    ds_read_b64_tr_b16 v[80:81], v11 offset:49152
    ds_read_b64_tr_b16 v[82:83], v11 offset:49664
    s_waitcnt lgkmcnt(4)
    v_mfma_f32_32x32x16_bf16 v[64:79], v[88:91], a[88:91], v[64:79]
    ds_read_b64_tr_b16 v[84:85], v11 offset:51200
    ds_read_b64_tr_b16 v[86:87], v11 offset:51712
    s_waitcnt lgkmcnt(4)
    v_mfma_f32_32x32x16_bf16 v[64:79], v[92:95], a[92:95], v[64:79]
    ds_read_b64_tr_b16 v[88:89], v11 offset:53248
    ds_read_b64_tr_b16 v[90:91], v11 offset:53760
    s_add_u32 s96, s15, 4
    s_cmp_ge_u32 s96, 5
    s_cselect_b32 s97, 5, 0
    s_sub_u32 s96, s96, s97
    s_lshl_b32 s97, s96, 13
    s_add_u32 s97, s97, s82
    s_lshl_b32 s96, s96, 16
    s_add_u32 s96, s96, s8
    s_add_u32 m0, s97, 8192
    s_nop 0
    buffer_load_dwordx4 v12, s[40:43], s96 offen lds
    s_waitcnt lgkmcnt(4)
    v_mfma_f32_32x32x16_bf16 v[64:79], v[80:83], a[96:99], v[64:79]
    ds_read_b64_tr_b16 v[92:93], v11 offset:55296
    ds_read_b64_tr_b16 v[94:95], v11 offset:55808
    s_waitcnt lgkmcnt(4)
    v_mfma_f32_32x32x16_bf16 v[64:79], v[84:87], a[100:103], v[64:79]
    ds_read_b64_tr_b16 v[80:81], v11 offset:57344
    ds_read_b64_tr_b16 v[82:83], v11 offset:57856
    s_waitcnt vmcnt(3)
    s_mov_b32 s94, 40000
L_gm_21:
    v_readfirstlane_b32 s89, v31
    s_nop 1
    s_and_b32 s90, s89, 31
    s_cselect_b32 s90, 0, s89
    s_cmp_lg_u32 s90, 0
    s_cbranch_scc1 L_gmd_22
    s_sub_u32 s94, s94, 1
    s_cbranch_scc1 L_gmd_22
    s_lshl_b32 s88, s68, 5
    buffer_load_dword v31, off, s[64:67], s88 sc1
    s_waitcnt vmcnt(0)
    s_branch L_gm_21
L_gmd_22:
    s_mul_i32 s90, s95, s95
    s_lshl_b32 s90, s90, 16
    s_lshl_b32 s91, s95, 8
    s_add_u32 s90, s90, s91
    s_add_u32 s90, s90, 1
    s_lshl_b32 s90, s90, 5
    s_cmp_eq_u32 s89, s90
    s_cselect_b32 s77, 1, 0
    s_add_u32 s88, s14, 0
    v_mov_b32 v25, s76
    s_mov_b64 exec, 1
    s_cmp_eq_u32 s77, 1
    s_cbranch_scc0 L_sl_23
    buffer_store_dword v25, off, s[48:51], s88
    s_branch L_sd_24
L_sl_23:
    buffer_store_dword v25, off, s[48:51], s88 sc1
L_sd_24:
    s_mov_b64 exec, -1
    s_waitcnt lgkmcnt(4)
    v_mfma_f32_32x32x16_bf16 v[64:79], v[88:91], a[104:107], v[64:79]
    ds_read_b64_tr_b16 v[84:85], v11 offset:59392
    ds_read_b64_tr_b16 v[86:87], v11 offset:59904
    s_add_u32 s96, s15, 0
    s_add_u32 s96, s96, s15
    s_cmp_ge_u32 s96, 6
    s_cselect_b32 s97, 6, 0
    s_sub_u32 s96, s96, s97
    s_cmp_ge_u32 s96, 6
    s_cselect_b32 s97, 6, 0
    s_sub_u32 s96, s96, s97
    s_lshl_b32 s97, s96, 13
    s_add_u32 s97, s97, s82
    s_lshl_b32 s96, s96, 16
    s_add_u32 s96, s96, s8
    s_add_u32 s96, s96, 327680
    s_add_u32 m0, s97, 49152
    s_nop 0
    buffer_load_dwordx4 v12, s[40:43], s96 offen lds
    s_waitcnt lgkmcnt(4)
    v_mfma_f32_32x32x16_bf16 v[64:79], v[92:95], a[108:111], v[64:79]
    ds_read_b64_tr_b16 v[88:89], v11 offset:61440
    ds_read_b64_tr_b16 v[90:91], v11 offset:61952
    s_waitcnt lgkmcnt(4)
    v_mfma_f32_32x32x16_bf16 v[64:79], v[80:83], a[112:115], v[64:79]
    ds_read_b64_tr_b16 v[92:93], v11 offset:63488
    ds_read_b64_tr_b16 v[94:95], v11 offset:64000
    s_waitcnt lgkmcnt(4)
    v_mfma_f32_32x32x16_bf16 v[64:79], v[84:87], a[116:119], v[64:79]
    s_add_u32 s96, s15, 1
    s_add_u32 s96, s96, s15
    s_cmp_ge_u32 s96, 6
    s_cselect_b32 s97, 6, 0
    s_sub_u32 s96, s96, s97
    s_cmp_ge_u32 s96, 6
    s_cselect_b32 s97, 6, 0
    s_sub_u32 s96, s96, s97
    s_lshl_b32 s97, s96, 13
    s_add_u32 s97, s97, s82
    s_lshl_b32 s96, s96, 16
    s_add_u32 s96, s96, s8
    s_add_u32 s96, s96, 327680
    s_add_u32 m0, s97, 49152
    s_nop 0
    buffer_load_dwordx4 v12, s[40:43], s96 offen lds
    s_waitcnt lgkmcnt(2)
    v_mfma_f32_32x32x16_bf16 v[64:79], v[88:91], a[120:123], v[64:79]
    s_waitcnt lgkmcnt(0)
    v_mfma_f32_32x32x16_bf16 v[64:79], v[92:95], a[124:127], v[64:79]
    s_add_u32 s96, s15, 2
    s_add_u32 s96, s96, s15
    s_cmp_ge_u32 s96, 6
    s_cselect_b32 s97, 6, 0
    s_sub_u32 s96, s96, s97
    s_cmp_ge_u32 s96, 6
    s_cselect_b32 s97, 6, 0
    s_sub_u32 s96, s96, s97
    s_lshl_b32 s97, s96, 13
    s_add_u32 s97, s97, s82
    s_lshl_b32 s96, s96, 16
    s_add_u32 s96, s96, s8
    s_add_u32 s96, s96, 327680
    s_add_u32 m0, s97, 49152
    s_nop 0
    buffer_load_dwordx4 v12, s[40:43], s96 offen lds
    s_barrier
    v_cvt_pk_bf16_f32 v80, v64, v65
    v_cvt_pk_bf16_f32 v81, v66, v67
    v_cvt_pk_bf16_f32 v82, v68, v69
    v_cvt_pk_bf16_f32 v83, v70, v71
    v_cvt_pk_bf16_f32 v84, v72, v73
    v_cvt_pk_bf16_f32 v85, v74, v75
    v_cvt_pk_bf16_f32 v86, v76, v77
    v_cvt_pk_bf16_f32 v87, v78, v79
    v_mfma_f32_32x32x16_bf16 v[32:47], v[104:107], v[80:83], 0
    s_nop 0
    v_mfma_f32_32x32x16_bf16 v[32:47], v[108:111], v[84:87], v[32:47]
    s_add_u32 s96, s15, 3
    s_add_u32 s96, s96, s15
    s_cmp_ge_u32 s96, 6
    s_cselect_b32 s97, 6, 0
    s_sub_u32 s96, s96, s97
    s_cmp_ge_u32 s96, 6
    s_cselect_b32 s97, 6, 0
    s_sub_u32 s96, s96, s97
    s_lshl_b32 s97, s96, 13
    s_add_u32 s97, s97, s82
    s_lshl_b32 s96, s96, 16
    s_add_u32 s96, s96, s8
    s_add_u32 s96, s96, 327680
    s_add_u32 m0, s97, 49152
    s_nop 0
    buffer_load_dwordx4 v12, s[40:43], s96 offen lds
    s_add_u32 s96, s15, 4
    s_add_u32 s96, s96, s15
    s_cmp_ge_u32 s96, 6
    s_cselect_b32 s97, 6, 0
    s_sub_u32 s96, s96, s97
    s_cmp_ge_u32 s96, 6
    s_cselect_b32 s97, 6, 0
    s_sub_u32 s96, s96, s97
    s_lshl_b32 s97, s96, 13
    s_add_u32 s97, s97, s82
    s_lshl_b32 s96, s96, 16
    s_add_u32 s96, s96, s8
    s_add_u32 s96, s96, 327680
    s_add_u32 m0, s97, 49152
    s_nop 0
    buffer_load_dwordx4 v12, s[40:43], s96 offen lds
    v_max3_f32 v80, v32, v33, v34
    v_max3_f32 v82, -v32, -v33, -v34
    v_max3_f32 v84, v40, v41, v42
    v_max3_f32 v86, -v40, -v41, -v42
    v_max3_f32 v80, v80, v35, v36
    v_max3_f32 v82, v82, -v35, -v36
    v_max3_f32 v84, v84, v43, v44
    v_max3_f32 v86, v86, -v43, -v44
    v_max3_f32 v80, v80, v37, v38
    v_max3_f32 v82, v82, -v37, -v38
    v_max3_f32 v84, v84, v45, v46
    v_max3_f32 v86, v86, -v45, -v46
    v_max_f32 v80, v80, v39
    v_max_f32_e64 v82, v82, -v39
    v_max_f32 v84, v84, v47
    v_max_f32_e64 v86, v86, -v47
    s_add_u32 s96, s15, 5
    s_add_u32 s96, s96, s15
    s_cmp_ge_u32 s96, 6
    s_cselect_b32 s97, 6, 0
    s_sub_u32 s96, s96, s97
    s_cmp_ge_u32 s96, 6
    s_cselect_b32 s97, 6, 0
    s_sub_u32 s96, s96, s97
    s_lshl_b32 s97, s96, 13
    s_add_u32 s97, s97, s82
    s_lshl_b32 s96, s96, 16
    s_add_u32 s96, s96, s8
    s_add_u32 s96, s96, 327680
    s_add_u32 m0, s97, 49152
    s_nop 0
    buffer_load_dwordx4 v12, s[40:43], s96 offen lds
    v_permlane32_swap_b32 v80, v82
    v_permlane32_swap_b32 v84, v86
    v_max_f32 v80, v80, v82
    v_max_f32 v84, v84, v86
    v_mul_f32 v80, s84, v80
    v_mul_f32 v84, s84, v84
    v_mov_b32 v82, v80
    v_mov_b32 v86, v84
    s_nop 0
    v_permlane32_swap_b32 v80, v82
    v_permlane32_swap_b32 v84, v86
    v_fma_f32 v48, v32, s84, -v80
    v_fma_f32 v49, v33, s84, -v80
    v_fma_f32 v50, v34, s84, -v80
    v_fma_f32 v51, v35, s84, -v80
    v_fma_f32 v52, v36, s84, -v80
    v_fma_f32 v53, v37, s84, -v80
    v_fma_f32 v54, v38, s84, -v80
    v_fma_f32 v55, v39, s84, -v80
    v_exp_f32 v48, v48
    v_exp_f32 v49, v49
    v_exp_f32 v50, v50
    v_exp_f32 v51, v51
    v_exp_f32 v52, v52
    v_exp_f32 v53, v53
    v_exp_f32 v54, v54
    v_exp_f32 v55, v55
    v_cvt_pk_bf16_f32 v112, v48, v49
    v_cvt_pk_bf16_f32 v113, v50, v51
    v_cvt_pk_bf16_f32 v114, v52, v53
    v_cvt_pk_bf16_f32 v115, v54, v55
    v_fma_f32 v56, -v32, s84, -v82
    v_fma_f32 v57, -v33, s84, -v82
    v_fma_f32 v58, -v34, s84, -v82
    v_fma_f32 v59, -v35, s84, -v82
    v_fma_f32 v60, -v36, s84, -v82
    v_fma_f32 v61, -v37, s84, -v82
    v_fma_f32 v62, -v38, s84, -v82
    v_fma_f32 v63, -v39, s84, -v82
    v_exp_f32 v56, v56
    v_exp_f32 v57, v57
    v_exp_f32 v58, v58
    v_exp_f32 v59, v59
    v_exp_f32 v60, v60
    v_exp_f32 v61, v61
    v_exp_f32 v62, v62
    v_exp_f32 v63, v63
    v_cvt_pk_bf16_f32 v116, v56, v57
    v_cvt_pk_bf16_f32 v117, v58, v59
    v_cvt_pk_bf16_f32 v118, v60, v61
    v_cvt_pk_bf16_f32 v119, v62, v63
    buffer_load_dword v24, v21, s[48:51], 0 offen sc1
    v_fma_f32 v64, v40, s84, -v84
    v_fma_f32 v65, v41, s84, -v84
    v_fma_f32 v66, v42, s84, -v84
    v_fma_f32 v67, v43, s84, -v84
    v_fma_f32 v68, v44, s84, -v84
    v_fma_f32 v69, v45, s84, -v84
    v_fma_f32 v70, v46, s84, -v84
    v_fma_f32 v71, v47, s84, -v84
    v_exp_f32 v64, v64
    v_exp_f32 v65, v65
    v_exp_f32 v66, v66
    v_exp_f32 v67, v67
    v_exp_f32 v68, v68
    v_exp_f32 v69, v69
    v_exp_f32 v70, v70
    v_exp_f32 v71, v71
    v_cvt_pk_bf16_f32 v120, v64, v65
    v_cvt_pk_bf16_f32 v121, v66, v67
    v_cvt_pk_bf16_f32 v122, v68, v69
    v_cvt_pk_bf16_f32 v123, v70, v71
    v_fma_f32 v72, -v40, s84, -v86
    v_fma_f32 v73, -v41, s84, -v86
    v_fma_f32 v74, -v42, s84, -v86
    v_fma_f32 v75, -v43, s84, -v86
    v_fma_f32 v76, -v44, s84, -v86
    v_fma_f32 v77, -v45, s84, -v86
    v_fma_f32 v78, -v46, s84, -v86
    v_fma_f32 v79, -v47, s84, -v86
    v_exp_f32 v72, v72
    v_exp_f32 v73, v73
    v_exp_f32 v74, v74
    v_exp_f32 v75, v75
    v_exp_f32 v76, v76
    v_exp_f32 v77, v77
    v_exp_f32 v78, v78
    v_exp_f32 v79, v79
    v_cvt_pk_bf16_f32 v124, v72, v73
    v_cvt_pk_bf16_f32 v125, v74, v75
    v_cvt_pk_bf16_f32 v126, v76, v77
    v_cvt_pk_bf16_f32 v127, v78, v79
    s_and_b32 s88, s69, 1
    s_lshl_b32 s88, s88, 2
    s_add_u32 s88, s88, s70
    s_sub_u32 s88, s88, 4
    s_lshl_b32 s90, s68, 7
    s_add_u32 s90, s90, s88
    s_lshl_b32 s91, s90, 10
    s_lshl_b32 s92, s72, 7
    s_add_u32 s91, s91, s92
    s_add_u32 s91, s91, 16777216
    v_lshrrev_b32 v26, 3, v0
    v_and_b32 v25, 7, v0
    v_lshlrev_b32 v25, 4, v25
    v_lshl_add_u32 v26, v26, 13, v25
    v_add_u32 v26, s91, v26
    s_lshl_b32 s91, s90, 6
    s_add_u32 s91, s91, 17825792
    v_lshrrev_b32 v28, 2, v0
    v_and_b32 v27, 3, v0
    v_lshlrev_b32 v27, 4, v27
    v_lshl_add_u32 v27, v28, 9, v27
    v_add_u32 v27, s91, v27
    s_lshl_b32 s90, s68, 3
    s_add_u32 s90, s90, s88
    s_lshl_b32 s91, s90, 10
    s_add_u32 s91, s91, s92
    s_add_u32 s91, s91, 17956864
    v_mov_b32 v30, 2147483632
    v_cmp_gt_u32 vcc, 8, v0
    v_add_u32 v28, s91, v25
    s_nop 0
    v_cndmask_b32 v28, v30, v28, vcc
    s_lshl_b32 s91, s90, 6
    s_add_u32 s91, s91, 18022400
    s_cmp_eq_u32 s72, 0
    s_cselect_b32 s91, s91, 2147483376
    v_cmp_gt_u32 vcc, 4, v0
    v_add_u32 v29, s91, v25
    s_nop 0
    v_cndmask_b32 v29, v30, v29, vcc
    s_mov_b32 s93, 0x10000
    buffer_load_dwordx4 v[88:91], v26, s[48:51], 0 offen sc1
    buffer_load_dwordx4 v[92:95], v26, s[48:51], s93 offen sc1
    buffer_load_dwordx4 v[96:99], v27, s[48:51], 0 offen sc1
    s_waitcnt vmcnt(0)
    s_mov_b32 s94, 40000
L_h1_25:
    v_cmp_ne_u32 vcc, s76, v91
    v_cmp_ne_u32 s[98:99], s76, v95
    s_nop 1
    s_or_b64 vcc, vcc, s[98:99]
    v_cmp_ne_u32 s[98:99], s76, v99
    s_nop 1
    s_or_b64 vcc, vcc, s[98:99]
    s_cbranch_vccz L_h1d_26
    s_sub_u32 s94, s94, 1
    s_cbranch_scc1 L_h1d_26
    s_mov_b32 s93, 0x10000
    buffer_load_dwordx4 v[88:91], v26, s[48:51], 0 offen sc1
    buffer_load_dwordx4 v[92:95], v26, s[48:51], s93 offen sc1
    buffer_load_dwordx4 v[96:99], v27, s[48:51], 0 offen sc1
    s_waitcnt vmcnt(0)
    s_branch L_h1_25
L_h1d_26:
    s_mov_b32 s89, 0x04000c0c
    s_mov_b32 s90, 0x0706000c
    v_perm_b32 v91, v90, v89, s89
    v_perm_b32 v91, v91, v88, s90
    v_perm_b32 v95, v94, v93, s89
    v_perm_b32 v95, v95, v92, s90
    v_perm_b32 v99, v98, v97, s89
    v_perm_b32 v99, v99, v96, s90
    v_add_f32 v88, v88, v92
    v_add_f32 v89, v89, v93
    v_add_f32 v90, v90, v94
    v_add_f32 v91, v91, v95
    v_add_f32_dpp v96, v96, v96 row_ror:4 row_mask:0xf bank_mask:0xf
    v_add_f32_dpp v97, v97, v97 row_ror:4 row_mask:0xf bank_mask:0xf
    v_add_f32_dpp v98, v98, v98 row_ror:4 row_mask:0xf bank_mask:0xf
    v_add_f32_dpp v99, v99, v99 row_ror:4 row_mask:0xf bank_mask:0xf
    v_add_f32_dpp v88, v88, v88 row_ror:8 row_mask:0xf bank_mask:0xf
    v_add_f32_dpp v89, v89, v89 row_ror:8 row_mask:0xf bank_mask:0xf
    v_add_f32_dpp v90, v90, v90 row_ror:8 row_mask:0xf bank_mask:0xf
    v_add_f32_dpp v91, v91, v91 row_ror:8 row_mask:0xf bank_mask:0xf
    v_add_f32_dpp v96, v96, v96 row_ror:8 row_mask:0xf bank_mask:0xf
    v_add_f32_dpp v97, v97, v97 row_ror:8 row_mask:0xf bank_mask:0xf
    v_add_f32_dpp v98, v98, v98 row_ror:8 row_mask:0xf bank_mask:0xf
    v_add_f32_dpp v99, v99, v99 row_ror:8 row_mask:0xf bank_mask:0xf
    v_mov_b32 v32, v88
    v_mov_b32 v33, v89
    v_mov_b32 v34, v90
    v_mov_b32 v35, v91
    v_mov_b32 v36, v96
    v_mov_b32 v37, v97
    v_mov_b32 v38, v98
    v_mov_b32 v39, v99
    v_permlane16_swap_b32 v88, v32
    v_permlane16_swap_b32 v89, v33
    v_permlane16_swap_b32 v90, v34
    v_permlane16_swap_b32 v91, v35
    v_permlane16_swap_b32 v96, v36
    v_permlane16_swap_b32 v97, v37
    v_permlane16_swap_b32 v98, v38
    v_permlane16_swap_b32 v99, v39
    v_add_f32 v88, v88, v32
    v_add_f32 v89, v89, v33
    v_add_f32 v90, v90, v34
    v_add_f32 v91, v91, v35
    v_add_f32 v96, v96, v36
    v_add_f32 v97, v97, v37
    v_add_f32 v98, v98, v38
    v_add_f32 v99, v99, v39
    v_mov_b32 v32, v88
    v_mov_b32 v33, v89
    v_mov_b32 v34, v90
    v_mov_b32 v35, v91
    v_mov_b32 v36, v96
    v_mov_b32 v37, v97
    v_mov_b32 v38, v98
    v_mov_b32 v39, v99
    v_permlane32_swap_b32 v88, v32
    v_permlane32_swap_b32 v89, v33
    v_permlane32_swap_b32 v90, v34
    v_permlane32_swap_b32 v91, v35
    v_permlane32_swap_b32 v96, v36
    v_permlane32_swap_b32 v97, v37
    v_permlane32_swap_b32 v98, v38
    v_permlane32_swap_b32 v99, v39
    v_add_f32 v88, v88, v32
    v_add_f32 v89, v89, v33
    v_add_f32 v90, v90, v34
    v_add_f32 v91, v91, v35
    v_add_f32 v96, v96, v36
    v_add_f32 v97, v97, v37
    v_add_f32 v98, v98, v38
    v_add_f32 v99, v99, v39
    v_cvt_pk_bf16_f32 v32, v88, v89
    v_cvt_pk_bf16_f32 v33, v90, v91
    v_mov_b32 v34, s76
    v_mov_b32 v35, s76
    v_cvt_pk_bf16_f32 v36, v96, v97
    v_cvt_pk_bf16_f32 v37, v98, v99
    v_mov_b32 v38, s76
    v_mov_b32 v39, s76
    buffer_store_dwordx4 v[32:35], v28, s[48:51], 0 offen sc1
    buffer_store_dwordx4 v[36:39], v29, s[48:51], 0 offen sc1
    s_mov_b32 s94, 40000
L_pf_27:
    v_cmp_ne_u32 vcc, s76, v24
    s_nop 1
    s_and_b32 s88, vcc_lo, 0x1f
    s_cbranch_scc0 L_pfd_28
    s_sub_u32 s94, s94, 1
    s_cbranch_scc1 L_pfd_28
    buffer_load_dword v24, v21, s[48:51], 0 offen sc1
    s_waitcnt vmcnt(0)
    s_branch L_pf_27
L_pfd_28:
    s_add_u32 s80, s5, 0
    s_cmp_ge_u32 s80, 5
    s_cselect_b32 s100, 5, 0
    s_sub_u32 s80, s80, s100
    s_lshl_b32 s80, s80, 13
    s_add_u32 s80, s80, s7
    buffer_load_dwordx4 a[0:3], v19, s[48:51], s80 offen offset:0 sc1
    s_add_u32 s80, s5, 1
    s_cmp_ge_u32 s80, 5
    s_cselect_b32 s100, 5, 0
    s_sub_u32 s80, s80, s100
    s_lshl_b32 s80, s80, 13
    s_add_u32 s80, s80, s7
    buffer_load_dwordx4 a[4:7], v19, s[48:51], s80 offen offset:0 sc1
    s_add_u32 s80, s5, 2
    s_cmp_ge_u32 s80, 5
    s_cselect_b32 s100, 5, 0
    s_sub_u32 s80, s80, s100
    s_lshl_b32 s80, s80, 13
    s_add_u32 s80, s80, s7
    buffer_load_dwordx4 a[8:11], v19, s[48:51], s80 offen offset:0 sc1
    s_add_u32 s80, s5, 3
    s_cmp_ge_u32 s80, 5
    s_cselect_b32 s100, 5, 0
    s_sub_u32 s80, s80, s100
    s_lshl_b32 s80, s80, 13
    s_add_u32 s80, s80, s7
    buffer_load_dwordx4 a[12:15], v19, s[48:51], s80 offen offset:0 sc1
    s_add_u32 s80, s5, 4
    s_cmp_ge_u32 s80, 5
    s_cselect_b32 s100, 5, 0
    s_sub_u32 s80, s80, s100
    s_lshl_b32 s80, s80, 13
    s_add_u32 s80, s80, s7
    buffer_load_dwordx4 a[16:19], v19, s[48:51], s80 offen offset:0 sc1
    s_add_u32 s80, s5, 5
    s_cmp_ge_u32 s80, 10
    s_cselect_b32 s100, 5, 0
    s_sub_u32 s80, s80, s100
    s_lshl_b32 s80, s80, 13
    s_add_u32 s80, s80, s7
    buffer_load_dwordx4 a[20:23], v19, s[48:51], s80 offen offset:0 sc1
    s_add_u32 s80, s5, 6
    s_cmp_ge_u32 s80, 10
    s_cselect_b32 s100, 5, 0
    s_sub_u32 s80, s80, s100
    s_lshl_b32 s80, s80, 13
    s_add_u32 s80, s80, s7
    buffer_load_dwordx4 a[24:27], v19, s[48:51], s80 offen offset:0 sc1
    s_add_u32 s80, s5, 7
    s_cmp_ge_u32 s80, 10
    s_cselect_b32 s100, 5, 0
    s_sub_u32 s80, s80, s100
    s_lshl_b32 s80, s80, 13
    s_add_u32 s80, s80, s7
    buffer_load_dwordx4 a[28:31], v19, s[48:51], s80 offen offset:0 sc1
    s_add_u32 s80, s5, 8
    s_cmp_ge_u32 s80, 10
    s_cselect_b32 s100, 5, 0
    s_sub_u32 s80, s80, s100
    s_lshl_b32 s80, s80, 13
    s_add_u32 s80, s80, s7
    buffer_load_dwordx4 a[32:35], v19, s[48:51], s80 offen offset:0 sc1
    s_add_u32 s80, s5, 9
    s_cmp_ge_u32 s80, 10
    s_cselect_b32 s100, 5, 0
    s_sub_u32 s80, s80, s100
    s_lshl_b32 s80, s80, 13
    s_add_u32 s80, s80, s7
    buffer_load_dwordx4 a[36:39], v19, s[48:51], s80 offen offset:0 sc1
    s_add_u32 s96, s15, 0
    s_and_b32 s96, s96, 3
    s_lshl_b32 s97, s15, 1
    s_and_b32 s97, s97, 4
    s_xor_b32 s97, s97, 4
    s_add_u32 s96, s96, s97
    s_lshl_b32 s97, s96, 13
    s_add_u32 s97, s97, s82
    s_lshl_b32 s96, s96, 16
    s_add_u32 m0, s97, 98304
    s_nop 0
    buffer_load_dwordx4 v12, s[44:47], s96 offen lds
    s_add_u32 s96, s15, 1
    s_and_b32 s96, s96, 3
    s_lshl_b32 s97, s15, 1
    s_and_b32 s97, s97, 4
    s_xor_b32 s97, s97, 4
    s_add_u32 s96, s96, s97
    s_lshl_b32 s97, s96, 13
    s_add_u32 s97, s97, s82
    s_lshl_b32 s96, s96, 16
    s_add_u32 m0, s97, 98304
    s_nop 0
    buffer_load_dwordx4 v12, s[44:47], s96 offen lds
    s_add_u32 s96, s15, 2
    s_and_b32 s96, s96, 3
    s_lshl_b32 s97, s15, 1
    s_and_b32 s97, s97, 4
    s_xor_b32 s97, s97, 4
    s_add_u32 s96, s96, s97
    s_lshl_b32 s97, s96, 13
    s_add_u32 s97, s97, s82
    s_lshl_b32 s96, s96, 16
    s_add_u32 m0, s97, 98304
    s_nop 0
    buffer_load_dwordx4 v12, s[44:47], s96 offen lds
    s_add_u32 s96, s15, 3
    s_and_b32 s96, s96, 3
    s_lshl_b32 s97, s15, 1
    s_and_b32 s97, s97, 4
    s_xor_b32 s97, s97, 4
    s_add_u32 s96, s96, s97
    s_lshl_b32 s97, s96, 13
    s_add_u32 s97, s97, s82
    s_lshl_b32 s96, s96, 16
    s_add_u32 m0, s97, 98304
    s_nop 0
    buffer_load_dwordx4 v12, s[44:47], s96 offen lds
    s_add_u32 s96, s15, 0
    s_and_b32 s96, s96, 3
    s_lshl_b32 s97, s15, 1
    s_and_b32 s97, s97, 4
    s_xor_b32 s97, s97, 0
    s_add_u32 s96, s96, s97
    s_lshl_b32 s97, s96, 13
    s_add_u32 s97, s97, s82
    s_lshl_b32 s96, s96, 16
    s_add_u32 m0, s97, 98304
    s_nop 0
    buffer_load_dwordx4 v12, s[44:47], s96 offen lds
    s_add_u32 s96, s15, 1
    s_and_b32 s96, s96, 3
    s_lshl_b32 s97, s15, 1
    s_and_b32 s97, s97, 4
    s_xor_b32 s97, s97, 0
    s_add_u32 s96, s96, s97
    s_lshl_b32 s97, s96, 13
    s_add_u32 s97, s97, s82
    s_lshl_b32 s96, s96, 16
    s_add_u32 m0, s97, 98304
    s_nop 0
    buffer_load_dwordx4 v12, s[44:47], s96 offen lds
    s_add_u32 s96, s15, 2
    s_and_b32 s96, s96, 3
    s_lshl_b32 s97, s15, 1
    s_and_b32 s97, s97, 4
    s_xor_b32 s97, s97, 0
    s_add_u32 s96, s96, s97
    s_lshl_b32 s97, s96, 13
    s_add_u32 s97, s97, s82
    s_lshl_b32 s96, s96, 16
    s_add_u32 m0, s97, 98304
    s_nop 0
    buffer_load_dwordx4 v12, s[44:47], s96 offen lds
    s_add_u32 s96, s15, 3
    s_and_b32 s96, s96, 3
    s_lshl_b32 s97, s15, 1
    s_and_b32 s97, s97, 4
    s_xor_b32 s97, s97, 0
    s_add_u32 s96, s96, s97
    s_lshl_b32 s97, s96, 13
    s_add_u32 s97, s97, s82
    s_lshl_b32 s96, s96, 16
    s_add_u32 m0, s97, 98304
    s_nop 0
    buffer_load_dwordx4 v12, s[44:47], s96 offen lds
    v_and_b32 v1, 31, v0
    v_lshrrev_b32 v25, 5, v0
    v_lshlrev_b32 v25, 1, v25
    v_and_b32 v26, 7, v0
    v_xor_b32 v25, v25, v26
    v_lshlrev_b32 v25, 4, v25
    v_lshl_add_u32 v1, v1, 8, v25
    s_and_b32 s92, s72, 1
    s_lshl_b32 s92, s92, 15
    s_lshr_b32 s89, s72, 1
    s_lshl_b32 s90, s89, 13
    s_add_u32 s90, s90, s92
    s_add_u32 s90, s90, 8192
    v_add_u32 v1, s90, v1
    v_xor_b32 v2, 16, v1
    v_xor_b32 v3, 64, v1
    v_xor_b32 v4, 0x50, v1
    v_lshrrev_b32 v27, 3, v0
    v_lshlrev_b32 v5, 1, v26
    v_xor_b32 v5, v5, v27
    v_lshlrev_b32 v5, 4, v5
    v_lshl_add_u32 v5, v27, 8, v5
    s_lshl_b32 s90, s89, 11
    s_add_u32 s90, s90, s92
    s_add_u32 s90, s90, 8192
    v_add_u32 v5, s90, v5
    v_xor_b32 v6, 16, v5
    s_lshl_b32 s90, s68, 8
    s_lshl_b32 s91, s15, 6
    s_add_u32 s90, s90, s91
    s_lshr_b32 s91, s92, 10
    s_add_u32 s90, s90, s91
    s_lshl_b32 s85, s90, 3
    s_add_u32 s85, s85, 17891328
    s_lshl_b32 s91, s89, 3
    s_add_u32 s90, s90, s91
    s_lshl_b32 s90, s90, 10
    s_lshl_b32 s91, s3, 7
    s_add_u32 s90, s90, s91
    v_lshlrev_b32 v26, 4, v26
    v_lshl_add_u32 v7, v27, 10, v26
    v_add_u32 v7, s90, v7
    s_lshl_b32 s90, s68, 2
    s_add_u32 s90, s90, s15
    s_lshl_b32 s90, s90, 3
    s_add_u32 s90, s90, s3
    s_lshl_b32 s90, s90, 14
    s_lshr_b32 s91, s92, 3
    s_add_u32 s90, s90, s91
    s_add_u32 s86, s90, 20971520
    s_barrier
    s_add_u32 s96, s5, 0
    s_cmp_ge_u32 s96, 5
    s_cselect_b32 s100, 5, 0
    s_sub_u32 s96, s96, s100
    s_lshl_b32 s96, s96, 13
    v_add_u32 v15, s96, v13
    v_add_u32 v16, s96, v14
    ds_read_b64_tr_b16 v[96:97], v15 offset:8192
    ds_read_b64_tr_b16 v[98:99], v15 offset:8704
    ds_read_b64_tr_b16 v[100:101], v16 offset:8192
    ds_read_b64_tr_b16 v[102:103], v16 offset:8704
    s_add_u32 s96, s5, 1
    s_cmp_ge_u32 s96, 5
    s_cselect_b32 s100, 5, 0
    s_sub_u32 s96, s96, s100
    s_lshl_b32 s96, s96, 13
    v_add_u32 v15, s96, v13
    v_add_u32 v16, s96, v14
    ds_read_b64_tr_b16 v[104:105], v15 offset:8192
    ds_read_b64_tr_b16 v[106:107], v15 offset:8704
    ds_read_b64_tr_b16 v[108:109], v16 offset:8192
    ds_read_b64_tr_b16 v[110:111], v16 offset:8704
    s_add_u32 s96, s5, 2
    s_cmp_ge_u32 s96, 5
    s_cselect_b32 s100, 5, 0
    s_sub_u32 s96, s96, s100
    s_lshl_b32 s96, s96, 13
    v_add_u32 v15, s96, v13
    v_add_u32 v16, s96, v14
    ds_read_b64_tr_b16 a[120:121], v15 offset:8192
    ds_read_b64_tr_b16 a[122:123], v15 offset:8704
    ds_read_b64_tr_b16 a[124:125], v16 offset:8192
    ds_read_b64_tr_b16 a[126:127], v16 offset:8704
    s_waitcnt vmcnt(17) lgkmcnt(8)
    v_mfma_f32_32x32x16_bf16 v[32:47], v[96:99], a[0:3], 0
    v_mfma_f32_32x32x16_bf16 v[48:63], v[100:103], a[0:3], 0
    s_add_u32 s96, s5, 3
    s_cmp_ge_u32 s96, 5
    s_cselect_b32 s100, 5, 0
    s_sub_u32 s96, s96, s100
    s_lshl_b32 s96, s96, 13
    v_add_u32 v15, s96, v13
    v_add_u32 v16, s96, v14
    ds_read_b64_tr_b16 v[96:97], v15 offset:8192
    ds_read_b64_tr_b16 v[98:99], v15 offset:8704
    ds_read_b64_tr_b16 v[100:101], v16 offset:8192
    ds_read_b64_tr_b16 v[102:103], v16 offset:8704
    s_waitcnt vmcnt(16) lgkmcnt(8)
    v_mfma_f32_32x32x16_bf16 v[32:47], v[104:107], a[4:7], v[32:47]
    v_mfma_f32_32x32x16_bf16 v[48:63], v[108:111], a[4:7], v[48:63]
    s_add_u32 s96, s5, 4
    s_cmp_ge_u32 s96, 5
    s_cselect_b32 s100, 5, 0
    s_sub_u32 s96, s96, s100
    s_lshl_b32 s96, s96, 13
    v_add_u32 v15, s96, v13
    v_add_u32 v16, s96, v14
    ds_read_b64_tr_b16 v[104:105], v15 offset:8192
    ds_read_b64_tr_b16 v[106:107], v15 offset:8704
    ds_read_b64_tr_b16 v[108:109], v16 offset:8192
    ds_read_b64_tr_b16 v[110:111], v16 offset:8704
    s_waitcnt vmcnt(15) lgkmcnt(8)
    v_mfma_f32_32x32x16_bf16 v[32:47], a[120:123], a[8:11], v[32:47]
    v_mfma_f32_32x32x16_bf16 v[48:63], a[124:127], a[8:11], v[48:63]
    s_lshl_b32 s88, s13, 3
    s_add_u32 s88, s88, s72
    s_lshl_b32 s4, s88, 10
    s_add_u32 s4, s4, 17956864
    s_lshl_b32 s6, s88, 6
    s_add_u32 s6, s6, 18022400
    v_and_b32 v28, 0x30, v22
    buffer_load_dwordx4 v[8:11], v22, s[48:51], s4 offen sc1
    buffer_load_dwordx4 v[28:31], v28, s[48:51], s6 offen sc1
    s_waitcnt vmcnt(16) lgkmcnt(4)
    v_mfma_f32_32x32x16_bf16 v[32:47], v[96:99], a[12:15], v[32:47]
    v_mfma_f32_32x32x16_bf16 v[48:63], v[100:103], a[12:15], v[48:63]
    s_barrier
    s_add_u32 s96, s5, 5
    s_cmp_ge_u32 s96, 10
    s_cselect_b32 s100, 5, 0
    s_sub_u32 s96, s96, s100
    s_lshl_b32 s96, s96, 13
    v_add_u32 v15, s96, v13
    v_add_u32 v16, s96, v14
    ds_read_b64_tr_b16 a[120:121], v15 offset:8192
    ds_read_b64_tr_b16 a[122:123], v15 offset:8704
    ds_read_b64_tr_b16 a[124:125], v16 offset:8192
    ds_read_b64_tr_b16 a[126:127], v16 offset:8704
    s_add_u32 s96, s5, 6
    s_cmp_ge_u32 s96, 10
    s_cselect_b32 s100, 5, 0
    s_sub_u32 s96, s96, s100
    s_lshl_b32 s96, s96, 13
    v_add_u32 v15, s96, v13
    v_add_u32 v16, s96, v14
    ds_read_b64_tr_b16 v[96:97], v15 offset:8192
    ds_read_b64_tr_b16 v[98:99], v15 offset:8704
    ds_read_b64_tr_b16 v[100:101], v16 offset:8192
    ds_read_b64_tr_b16 v[102:103], v16 offset:8704
    s_waitcnt vmcnt(15) lgkmcnt(8)
    v_mfma_f32_32x32x16_bf16 v[32:47], v[104:107], a[16:19], v[32:47]
    v_mfma_f32_32x32x16_bf16 v[48:63], v[108:111], a[16:19], v[48:63]
    s_waitcnt lgkmcnt(0)
    s_waitcnt vmcnt(0)
    s_mov_b32 s94, 40000
L_h2_29:
    v_cmp_ne_u32 vcc, s76, v10
    v_cmp_ne_u32 s[98:99], s76, v30
    s_nop 1
    s_or_b64 vcc, vcc, s[98:99]
    s_cbranch_vccz L_h2d_30
    s_sub_u32 s94, s94, 1
    s_cbranch_scc1 L_h2d_30
    v_and_b32 v28, 0x30, v22
    buffer_load_dwordx4 v[8:11], v22, s[48:51], s4 offen sc1
    buffer_load_dwordx4 v[28:31], v28, s[48:51], s6 offen sc1
    s_waitcnt vmcnt(0)
    s_branch L_h2_29
L_h2d_30:
    s_add_u32 s88, s82, 0
    v_and_b32 v26, 15, v0
    v_lshrrev_b32 v27, 4, v0
    v_lshlrev_b32 v27, 3, v27
    v_lshl_add_u32 v26, v26, 5, v27
    v_add_u32 v26, s88, v26
    v_lshlrev_b32 v27, 3, v0
    v_add_u32 v27, s88, v27
    ds_write_b64 v26, v[8:9]
    v_cmp_gt_u32 vcc, 4, v0
    v_mov_b32 v25, 0x3f803f80
    s_nop 0
    v_cndmask_b32 v28, v25, v28, vcc
    v_cndmask_b32 v29, v25, v29, vcc
    s_mov_b64 exec, 0xff
    ds_write_b64 v27, v[28:29] offset:512
    s_mov_b64 exec, -1
    v_and_b32 v27, 3, v0
    v_bfe_u32 v25, v0, 2, 1
    v_bfe_u32 v26, v0, 3, 1
    v_lshl_add_u32 v27, v25, 3, v27
    v_lshl_add_u32 v27, v26, 2, v27
    v_add_u32 v26, 16, v26
    v_and_b32 v25, 16, v0
    v_cmp_eq_u32 vcc, 0, v25
    v_lshrrev_b32 v25, 5, v0
    v_lshlrev_b32 v25, 4, v25
    v_cndmask_b32 v27, v26, v27, vcc
    v_lshl_add_u32 v27, v27, 5, v25
    s_lshl_b32 s88, s74, 12
    s_add_u32 s88, s88, 0
    v_add_u32 v27, s88, v27
    s_waitcnt lgkmcnt(0)
    s_barrier
    ds_read_b128 v[8:11], v27 offset:0
    ds_read_b128 v[28:31], v27 offset:1024
    ds_read_b128 a[112:115], v27 offset:2048
    ds_read_b128 a[116:119], v27 offset:3072
    s_lshl_b32 s88, s13, 13
    s_add_u32 s88, s88, 180224
    s_add_u32 s89, s88, 2048
    s_mov_b32 s90, 0x358637bd
    s_waitcnt lgkmcnt(2)
    v_mfma_f32_32x32x16_bf16 v[80:95], v[28:31], v[116:119], 0
    v_mfma_f32_32x32x16_bf16 v[64:79], v[8:11], v[112:115], 0
    s_nop 10
    v_rcp_f32 v25, v92
    v_fma_f32 v26, v76, s90, v72
    v_mul_f32 v25, v76, v25
    v_fmac_f32 v26, v25, v88
    v_rcp_f32 v26, v26
    v_fmac_f32 v64, v25, v80
    v_fmac_f32 v65, v25, v81
    v_fmac_f32 v66, v25, v82
    v_fmac_f32 v67, v25, v83
    v_fmac_f32 v68, v25, v84
    v_fmac_f32 v69, v25, v85
    v_fmac_f32 v70, v25, v86
    v_fmac_f32 v71, v25, v87
    s_waitcnt lgkmcnt(0)
    v_mfma_f32_32x32x16_bf16 v[80:95], a[116:119], v[124:127], 0
    v_mul_f32 v64, v26, v64
    v_mul_f32 v65, v26, v65
    v_mul_f32 v66, v26, v66
    v_mul_f32 v67, v26, v67
    v_mul_f32 v68, v26, v68
    v_mul_f32 v69, v26, v69
    v_mul_f32 v70, v26, v70
    v_mul_f32 v71, v26, v71
    v_cvt_pk_bf16_f32 v112, v64, v65
    v_cvt_pk_bf16_f32 v113, v66, v67
    v_cvt_pk_bf16_f32 v114, v68, v69
    v_cvt_pk_bf16_f32 v115, v70, v71
    v_mfma_f32_32x32x16_bf16 v[64:79], a[112:115], v[120:123], 0
    v_rcp_f32 v25, v92
    s_nop 10
    v_fma_f32 v26, v76, s90, v72
    v_mul_f32 v25, v76, v25
    v_fmac_f32 v26, v25, v88
    v_rcp_f32 v26, v26
    v_fmac_f32 v64, v25, v80
    v_fmac_f32 v65, v25, v81
    v_fmac_f32 v66, v25, v82
    v_fmac_f32 v67, v25, v83
    v_fmac_f32 v68, v25, v84
    v_fmac_f32 v69, v25, v85
    v_fmac_f32 v70, v25, v86
    v_fmac_f32 v71, v25, v87
    v_mul_f32 v64, v26, v64
    v_mul_f32 v65, v26, v65
    v_mul_f32 v66, v26, v66
    v_mul_f32 v67, v26, v67
    v_mul_f32 v68, v26, v68
    v_mul_f32 v69, v26, v69
    v_mul_f32 v70, v26, v70
    v_mul_f32 v71, v26, v71
    v_cvt_pk_bf16_f32 v120, v64, v65
    v_cvt_pk_bf16_f32 v121, v66, v67
    v_cvt_pk_bf16_f32 v122, v68, v69
    v_cvt_pk_bf16_f32 v123, v70, v71
    s_cmp_eq_u32 s77, 1
    s_cbranch_scc0 L_sl_31
    buffer_store_dwordx4 v[112:115], v20, s[48:51], s88 offen sc1
    buffer_store_dwordx4 v[120:123], v20, s[48:51], s89 offen sc1
    s_branch L_sd_32
L_sl_31:
    buffer_store_dwordx4 v[112:115], v20, s[48:51], s88 offen sc1
    buffer_store_dwordx4 v[120:123], v20, s[48:51], s89 offen sc1
L_sd_32:
    s_add_u32 s96, s5, 7
    s_cmp_ge_u32 s96, 10
    s_cselect_b32 s100, 5, 0
    s_sub_u32 s96, s96, s100
    s_lshl_b32 s96, s96, 13
    v_add_u32 v15, s96, v13
    v_add_u32 v16, s96, v14
    ds_read_b64_tr_b16 v[104:105], v15 offset:8192
    ds_read_b64_tr_b16 v[106:107], v15 offset:8704
    ds_read_b64_tr_b16 v[108:109], v16 offset:8192
    ds_read_b64_tr_b16 v[110:111], v16 offset:8704
    v_mfma_f32_32x32x16_bf16 v[32:47], a[120:123], a[20:23], v[32:47]
    v_mfma_f32_32x32x16_bf16 v[48:63], a[124:127], a[20:23], v[48:63]
    buffer_load_dword v24, v21, s[48:51], 0 offen sc1
    s_add_u32 s96, s5, 8
    s_cmp_ge_u32 s96, 10
    s_cselect_b32 s100, 5, 0
    s_sub_u32 s96, s96, s100
    s_lshl_b32 s96, s96, 13
    v_add_u32 v15, s96, v13
    v_add_u32 v16, s96, v14
    ds_read_b64_tr_b16 a[120:121], v15 offset:8192
    ds_read_b64_tr_b16 a[122:123], v15 offset:8704
    ds_read_b64_tr_b16 a[124:125], v16 offset:8192
    ds_read_b64_tr_b16 a[126:127], v16 offset:8704
    v_mfma_f32_32x32x16_bf16 v[32:47], v[96:99], a[24:27], v[32:47]
    v_mfma_f32_32x32x16_bf16 v[48:63], v[100:103], a[24:27], v[48:63]
    s_waitcnt vmcnt(1)
    s_and_b32 s89, s69, 1
    s_lshl_b32 s88, s68, 1
    s_add_u32 s88, s88, s89
    s_lshl_b32 s88, s88, 2
    s_add_u32 s88, s88, s73
    s_lshl_b32 s88, s88, 1
    s_add_u32 s88, s88, s74
    s_lshl_b32 s88, s88, 4
    s_add_u32 s88, s88, s13
    s_lshl_b32 s88, s88, 2
    s_add_u32 s88, s88, 18104320
    v_mov_b32 v25, s76
    s_mov_b64 exec, 1
    s_cmp_eq_u32 s77, 1
    s_cbranch_scc0 L_sl_33
    buffer_store_dword v25, off, s[48:51], s88
    s_branch L_sd_34
L_sl_33:
    buffer_store_dword v25, off, s[48:51], s88 sc1
L_sd_34:
    s_mov_b64 exec, -1
    s_add_u32 s96, s5, 9
    s_cmp_ge_u32 s96, 10
    s_cselect_b32 s100, 5, 0
    s_sub_u32 s96, s96, s100
    s_lshl_b32 s96, s96, 13
    v_add_u32 v15, s96, v13
    v_add_u32 v16, s96, v14
    ds_read_b64_tr_b16 v[96:97], v15 offset:8192
    ds_read_b64_tr_b16 v[98:99], v15 offset:8704
    ds_read_b64_tr_b16 v[100:101], v16 offset:8192
    ds_read_b64_tr_b16 v[102:103], v16 offset:8704
    s_waitcnt lgkmcnt(8)
    v_mfma_f32_32x32x16_bf16 v[32:47], v[104:107], a[28:31], v[32:47]
    v_mfma_f32_32x32x16_bf16 v[48:63], v[108:111], a[28:31], v[48:63]
    s_waitcnt vmcnt(1)
    s_mov_b32 s94, 40000
L_pf_35:
    v_cmp_ne_u32 vcc, s76, v24
    s_nop 1
    s_and_b32 s88, vcc_lo, 0x1000
    s_cbranch_scc0 L_pfd_36
    s_sub_u32 s94, s94, 1
    s_cbranch_scc1 L_pfd_36
    buffer_load_dword v24, v21, s[48:51], 0 offen sc1
    s_waitcnt vmcnt(0)
    s_branch L_pf_35
L_pfd_36:
    s_mov_b32 s80, 10
    s_lshl_b32 s80, s80, 13
    s_add_u32 s80, s80, s7
    s_and_b32 s100, s16, s74
    s_cselect_b32 s80, 0x40000000, s80
    buffer_load_dwordx4 a[40:43], v19, s[48:51], s80 offen offset:0 sc1
    s_mov_b32 s96, 10
    s_lshl_b32 s96, s96, 13
    v_add_u32 v15, s96, v13
    v_add_u32 v16, s96, v14
    ds_read_b64_tr_b16 v[104:105], v15 offset:8192
    ds_read_b64_tr_b16 v[106:107], v15 offset:8704
    ds_read_b64_tr_b16 v[108:109], v16 offset:8192
    ds_read_b64_tr_b16 v[110:111], v16 offset:8704
    s_waitcnt lgkmcnt(8)
    v_mfma_f32_32x32x16_bf16 v[32:47], a[120:123], a[32:35], v[32:47]
    v_mfma_f32_32x32x16_bf16 v[48:63], a[124:127], a[32:35], v[48:63]
    s_waitcnt lgkmcnt(4)
    v_mfma_f32_32x32x16_bf16 v[32:47], v[96:99], a[36:39], v[32:47]
    v_mfma_f32_32x32x16_bf16 v[48:63], v[100:103], a[36:39], v[48:63]
    s_waitcnt vmcnt(0) lgkmcnt(0)
    v_mfma_f32_32x32x16_bf16 v[32:47], v[104:107], a[40:43], v[32:47]
    v_mfma_f32_32x32x16_bf16 v[48:63], v[108:111], a[40:43], v[48:63]
    s_mov_b32 s56, s20
    s_mov_b32 s57, s21
    s_mov_b32 s58, 2097152
    s_mov_b32 s59, 0x20000
    v_and_b32 v26, 31, v0
    v_lshlrev_b32 v26, 3, v26
    v_and_b32 v28, 0x38, v0
    s_lshr_b32 s89, s72, 1
    s_lshl_b32 s89, s89, 6
    s_add_u32 s89, s89, s85
    buffer_load_dwordx2 v[26:27], v26, s[48:51], s85 offen sc1
    buffer_load_dwordx2 v[28:29], v28, s[48:51], s89 offen sc1
    buffer_load_dword v24, v21, s[48:51], 0 offen sc1
    s_barrier
    ds_read_b64_tr_b16 v[96:97], v17 offset:0
    ds_read_b64_tr_b16 v[98:99], v17 offset:512
    ds_read_b64_tr_b16 v[100:101], v18 offset:0
    ds_read_b64_tr_b16 v[102:103], v18 offset:512
    s_waitcnt vmcnt(1)
    s_mov_b32 s94, 40000
L_sp_37:
    v_cmp_ne_u32 vcc, s76, v27
    v_cmp_ne_u32 s[98:99], s76, v29
    s_nop 1
    s_or_b64 vcc, vcc, s[98:99]
    s_cbranch_vccz L_spd_38
    s_sub_u32 s94, s94, 1
    s_cbranch_scc1 L_spd_38
    v_and_b32 v26, 31, v0
    v_lshlrev_b32 v26, 3, v26
    v_and_b32 v28, 0x38, v0
    s_lshr_b32 s89, s72, 1
    s_lshl_b32 s89, s89, 6
    s_add_u32 s89, s89, s85
    buffer_load_dwordx2 v[26:27], v26, s[48:51], s85 offen sc1
    buffer_load_dwordx2 v[28:29], v28, s[48:51], s89 offen sc1
    s_waitcnt vmcnt(0)
    s_branch L_sp_37
L_spd_38:
    s_waitcnt vmcnt(0)
    s_mov_b32 s94, 40000
L_pf_39:
    v_cmp_ne_u32 vcc, s76, v24
    s_nop 1
    s_and_b32 s88, vcc_hi, 0xff
    s_cbranch_scc0 L_pfd_40
    s_sub_u32 s94, s94, 1
    s_cbranch_scc1 L_pfd_40
    buffer_load_dword v24, v21, s[48:51], 0 offen sc1
    s_waitcnt vmcnt(0)
    s_branch L_pf_39
L_pfd_40:
    s_lshl_b32 s93, s16, 21
    s_add_u32 s93, s93, 180224
    s_add_u32 s88, s93, 0
    buffer_load_dwordx4 a[0:3], v19, s[48:51], s88 offen sc1
    v_sub_f32 v27, 1.0, v26
    v_sub_f32 v28, 1.0, v28
    v_mul_f32 v32, v27, v32
    v_mul_f32 v33, v27, v33
    v_mul_f32 v34, v27, v34
    v_mul_f32 v35, v27, v35
    v_mul_f32 v36, v27, v36
    s_add_u32 s88, s93, 8192
    buffer_load_dwordx4 a[4:7], v19, s[48:51], s88 offen sc1
    v_mul_f32 v37, v27, v37
    v_mul_f32 v38, v27, v38
    v_mul_f32 v39, v27, v39
    v_mul_f32 v40, v27, v40
    v_mul_f32 v41, v27, v41
    s_add_u32 s88, s93, 16384
    buffer_load_dwordx4 a[8:11], v19, s[48:51], s88 offen sc1
    v_mul_f32 v42, v27, v42
    v_mul_f32 v43, v27, v43
    v_mul_f32 v44, v27, v44
    v_mul_f32 v45, v27, v45
    v_mul_f32 v46, v27, v46
    v_mul_f32 v47, v27, v47
    s_add_u32 s88, s93, 24576
    buffer_load_dwordx4 a[12:15], v19, s[48:51], s88 offen sc1
    v_mul_f32 v48, v27, v48
    v_mul_f32 v49, v27, v49
    v_mul_f32 v50, v27, v50
    v_mul_f32 v51, v27, v51
    v_mul_f32 v52, v27, v52
    s_add_u32 s88, s93, 32768
    buffer_load_dwordx4 a[16:19], v19, s[48:51], s88 offen sc1
    v_mul_f32 v53, v27, v53
    v_mul_f32 v54, v27, v54
    v_mul_f32 v55, v27, v55
    v_mul_f32 v56, v27, v56
    v_mul_f32 v57, v27, v57
    s_add_u32 s88, s93, 40960
    buffer_load_dwordx4 a[20:23], v19, s[48:51], s88 offen sc1
    v_mul_f32 v58, v27, v58
    v_mul_f32 v59, v27, v59
    v_mul_f32 v60, v27, v60
    v_mul_f32 v61, v27, v61
    v_mul_f32 v62, v27, v62
    v_mul_f32 v63, v27, v63
    ds_read_b64_tr_b16 v[104:105], v17 offset:8192
    ds_read_b64_tr_b16 v[106:107], v17 offset:8704
    ds_read_b64_tr_b16 v[108:109], v18 offset:8192
    ds_read_b64_tr_b16 v[110:111], v18 offset:8704
    s_add_u32 s88, s93, 49152
    buffer_load_dwordx4 a[24:27], v19, s[48:51], s88 offen sc1
    buffer_load_dword v24, v21, s[48:51], 0 offen sc1
    s_waitcnt vmcnt(7) lgkmcnt(4)
    v_mfma_f32_32x32x16_bf16 v[64:79], v[96:99], a[0:3], 0
    v_mfma_f32_32x32x16_bf16 v[80:95], v[100:103], a[0:3], 0
    ds_read_b64_tr_b16 v[96:97], v17 offset:16384
    ds_read_b64_tr_b16 v[98:99], v17 offset:16896
    ds_read_b64_tr_b16 v[100:101], v18 offset:16384
    ds_read_b64_tr_b16 v[102:103], v18 offset:16896
    s_add_u32 s88, s93, 57344
    buffer_load_dwordx4 a[28:31], v19, s[48:51], s88 offen sc1
    s_waitcnt vmcnt(7) lgkmcnt(4)
    v_mfma_f32_32x32x16_bf16 v[64:79], v[104:107], a[4:7], v[64:79]
    v_mfma_f32_32x32x16_bf16 v[80:95], v[108:111], a[4:7], v[80:95]
    ds_read_b64_tr_b16 v[104:105], v17 offset:24576
    ds_read_b64_tr_b16 v[106:107], v17 offset:25088
    ds_read_b64_tr_b16 v[108:109], v18 offset:24576
    ds_read_b64_tr_b16 v[110:111], v18 offset:25088
    s_waitcnt vmcnt(6) lgkmcnt(4)
    v_mfma_f32_32x32x16_bf16 v[64:79], v[96:99], a[8:11], v[64:79]
    v_mfma_f32_32x32x16_bf16 v[80:95], v[100:103], a[8:11], v[80:95]
    ds_read_b64_tr_b16 v[96:97], v17 offset:32768
    ds_read_b64_tr_b16 v[98:99], v17 offset:33280
    ds_read_b64_tr_b16 v[100:101], v18 offset:32768
    ds_read_b64_tr_b16 v[102:103], v18 offset:33280
    s_waitcnt vmcnt(5) lgkmcnt(4)
    v_mfma_f32_32x32x16_bf16 v[64:79], v[104:107], a[12:15], v[64:79]
    v_mfma_f32_32x32x16_bf16 v[80:95], v[108:111], a[12:15], v[80:95]
    ds_read_b64_tr_b16 v[104:105], v17 offset:40960
    ds_read_b64_tr_b16 v[106:107], v17 offset:41472
    ds_read_b64_tr_b16 v[108:109], v18 offset:40960
    ds_read_b64_tr_b16 v[110:111], v18 offset:41472
    s_waitcnt vmcnt(1)
    s_mov_b32 s94, 40000
L_pf_41:
    v_cmp_ne_u32 vcc, s76, v24
    s_nop 1
    s_and_b32 s88, vcc_hi, 0x30000
    s_cbranch_scc0 L_pfd_42
    s_sub_u32 s94, s94, 1
    s_cbranch_scc1 L_pfd_42
    buffer_load_dword v24, v21, s[48:51], 0 offen sc1
    s_waitcnt vmcnt(0)
    s_branch L_pf_41
L_pfd_42:
    s_xor_b32 s90, s86, 524288
    s_lshr_b32 s91, s72, 1
    s_lshl_b32 s91, s91, 7
    s_add_u32 s90, s90, s91
    v_bfe_u32 v8, v0, 1, 2
    v_and_b32 v9, 1, v0
    v_lshlrev_b32 v8, 10, v8
    v_lshl_add_u32 v8, v9, 9, v8
    v_lshrrev_b32 v9, 3, v0
    v_lshl_add_u32 v8, v9, 4, v8
    buffer_load_dwordx4 v[120:123], v8, s[48:51], s90 offen sc1
    s_waitcnt lgkmcnt(4)
    v_mfma_f32_32x32x16_bf16 v[64:79], v[96:99], a[16:19], v[64:79]
    v_mfma_f32_32x32x16_bf16 v[80:95], v[100:103], a[16:19], v[80:95]
    ds_read_b64_tr_b16 v[96:97], v17 offset:49152
    ds_read_b64_tr_b16 v[98:99], v17 offset:49664
    ds_read_b64_tr_b16 v[100:101], v18 offset:49152
    ds_read_b64_tr_b16 v[102:103], v18 offset:49664
    s_waitcnt lgkmcnt(4)
    v_mfma_f32_32x32x16_bf16 v[64:79], v[104:107], a[20:23], v[64:79]
    v_mfma_f32_32x32x16_bf16 v[80:95], v[108:111], a[20:23], v[80:95]
    ds_read_b64_tr_b16 v[104:105], v17 offset:57344
    ds_read_b64_tr_b16 v[106:107], v17 offset:57856
    ds_read_b64_tr_b16 v[108:109], v18 offset:57344
    ds_read_b64_tr_b16 v[110:111], v18 offset:57856
    s_waitcnt lgkmcnt(4)
    v_mfma_f32_32x32x16_bf16 v[64:79], v[96:99], a[24:27], v[64:79]
    v_mfma_f32_32x32x16_bf16 v[80:95], v[100:103], a[24:27], v[80:95]
    s_waitcnt vmcnt(1) lgkmcnt(0)
    v_mfma_f32_32x32x16_bf16 v[64:79], v[104:107], a[28:31], v[64:79]
    v_mfma_f32_32x32x16_bf16 v[80:95], v[108:111], a[28:31], v[80:95]
    s_nop 10
    v_pk_fma_f32 v[32:33], v[64:65], v[26:27], v[32:33] op_sel_hi:[1,0,1]
    v_pk_fma_f32 v[34:35], v[66:67], v[26:27], v[34:35] op_sel_hi:[1,0,1]
    ds_write_b128 v1, v[32:35] offset:0
    v_pk_fma_f32 v[36:37], v[68:69], v[26:27], v[36:37] op_sel_hi:[1,0,1]
    v_pk_fma_f32 v[38:39], v[70:71], v[26:27], v[38:39] op_sel_hi:[1,0,1]
    ds_write_b128 v2, v[36:39] offset:0
    v_pk_fma_f32 v[40:41], v[72:73], v[26:27], v[40:41] op_sel_hi:[1,0,1]
    v_pk_fma_f32 v[42:43], v[74:75], v[26:27], v[42:43] op_sel_hi:[1,0,1]
    ds_write_b128 v3, v[40:43] offset:0
    v_pk_fma_f32 v[44:45], v[76:77], v[26:27], v[44:45] op_sel_hi:[1,0,1]
    v_pk_fma_f32 v[46:47], v[78:79], v[26:27], v[46:47] op_sel_hi:[1,0,1]
    ds_write_b128 v4, v[44:47] offset:0
    v_pk_fma_f32 v[48:49], v[80:81], v[26:27], v[48:49] op_sel_hi:[1,0,1]
    v_pk_fma_f32 v[50:51], v[82:83], v[26:27], v[50:51] op_sel_hi:[1,0,1]
    ds_write_b128 v1, v[48:51] offset:128
    v_pk_fma_f32 v[52:53], v[84:85], v[26:27], v[52:53] op_sel_hi:[1,0,1]
    v_pk_fma_f32 v[54:55], v[86:87], v[26:27], v[54:55] op_sel_hi:[1,0,1]
    ds_write_b128 v2, v[52:55] offset:128
    v_pk_fma_f32 v[56:57], v[88:89], v[26:27], v[56:57] op_sel_hi:[1,0,1]
    v_pk_fma_f32 v[58:59], v[90:91], v[26:27], v[58:59] op_sel_hi:[1,0,1]
    ds_write_b128 v3, v[56:59] offset:128
    v_pk_fma_f32 v[60:61], v[92:93], v[26:27], v[60:61] op_sel_hi:[1,0,1]
    v_pk_fma_f32 v[62:63], v[94:95], v[26:27], v[62:63] op_sel_hi:[1,0,1]
    ds_write_b128 v4, v[60:63] offset:128
    s_waitcnt vmcnt(0)
    v_lshlrev_b32 v112, 16, v120
    v_and_b32 v113, 0xffff0000, v120
    v_lshlrev_b32 v114, 16, v121
    v_and_b32 v115, 0xffff0000, v121
    v_lshlrev_b32 v116, 16, v122
    v_and_b32 v117, 0xffff0000, v122
    v_lshlrev_b32 v118, 16, v123
    v_and_b32 v119, 0xffff0000, v123
    s_waitcnt lgkmcnt(0)
    s_barrier
    ds_read_b128 v[64:67], v5 offset:0
    ds_read_b128 v[68:71], v6 offset:0
    ds_read_b128 v[72:75], v5 offset:8192
    ds_read_b128 v[76:79], v6 offset:8192
    ds_read_b128 v[80:83], v5 offset:16384
    ds_read_b128 v[84:87], v6 offset:16384
    ds_read_b128 v[88:91], v5 offset:24576
    ds_read_b128 v[92:95], v6 offset:24576
    s_waitcnt lgkmcnt(4)
    v_pk_add_f32 v[64:65], v[64:65], v[72:73]
    v_pk_add_f32 v[66:67], v[66:67], v[74:75]
    v_pk_add_f32 v[68:69], v[68:69], v[76:77]
    v_pk_add_f32 v[70:71], v[70:71], v[78:79]
    s_waitcnt lgkmcnt(0)
    v_pk_add_f32 v[80:81], v[80:81], v[88:89]
    v_pk_add_f32 v[82:83], v[82:83], v[90:91]
    v_pk_add_f32 v[84:85], v[84:85], v[92:93]
    v_pk_add_f32 v[86:87], v[86:87], v[94:95]
    v_pk_add_f32 v[64:65], v[64:65], v[80:81]
    v_pk_add_f32 v[66:67], v[66:67], v[82:83]
    v_pk_add_f32 v[68:69], v[68:69], v[84:85]
    v_pk_add_f32 v[70:71], v[70:71], v[86:87]
    v_pk_fma_f32 v[64:65], v[112:113], v[28:29], v[64:65] op_sel_hi:[1,0,1]
    v_pk_fma_f32 v[66:67], v[114:115], v[28:29], v[66:67] op_sel_hi:[1,0,1]
    v_pk_fma_f32 v[68:69], v[116:117], v[28:29], v[68:69] op_sel_hi:[1,0,1]
    v_pk_fma_f32 v[70:71], v[118:119], v[28:29], v[70:71] op_sel_hi:[1,0,1]
    v_cvt_pk_bf16_f32 v72, v64, v65
    v_cvt_pk_bf16_f32 v73, v66, v67
    v_cvt_pk_bf16_f32 v74, v68, v69
    v_cvt_pk_bf16_f32 v75, v70, v71
    buffer_store_dwordx4 v[72:75], v7, s[56:59], 0 offen nt
    s_endpgm
L_kv:
    s_mov_b32 s60, s18
    s_mov_b32 s61, s19
    s_mov_b32 s62, 1024
    s_mov_b32 s63, 0x20000
    s_lshl_b32 s88, s70, 2
    s_lshr_b32 s89, s72, 1
    s_add_u32 s88, s88, s89
    s_cmp_eq_u32 s88, 46
    s_cbranch_scc0 L_gi_43
    v_lshrrev_b32 v24, 3, v0
    v_add_u32 v24, s75, v24
    v_and_b32 v24, 7, v24
    v_and_b32 v25, 0x70, v22
    v_lshl_add_u32 v24, v24, 7, v25
    s_and_b32 s89, s72, 1
    s_lshl_b32 s88, s89, 10
    s_mov_b32 m0, s88
    s_lshl_b32 s89, s89, 16
    buffer_load_dwordx4 v24, s[60:63], s89 offen lds
    s_branch L_gid_44
L_gi_43:
    buffer_load_dword v30, off, s[60:63], 0
L_gid_44:
    v_and_b32 v28, 31, v0
    v_lshrrev_b32 v29, 5, v0
    v_lshlrev_b32 v29, 4, v29
    v_lshl_add_u32 v28, v28, 5, v29
    s_lshl_b32 s88, s73, 10
    s_add_u32 s88, s88, 49152
    s_lshl_b32 s89, s74, 13
    s_add_u32 s90, s88, s89
    s_add_u32 s91, s90, s89
    v_add_u32 v29, s90, v28
    v_add_u32 v28, s91, v28
    v_cvt_pk_bf16_f32 v96, v32, v33
    v_cvt_pk_bf16_f32 v97, v34, v35
    v_cvt_pk_bf16_f32 v98, v36, v37
    v_cvt_pk_bf16_f32 v99, v38, v39
    v_cvt_pk_bf16_f32 v100, v40, v41
    v_cvt_pk_bf16_f32 v101, v42, v43
    v_cvt_pk_bf16_f32 v102, v44, v45
    v_cvt_pk_bf16_f32 v103, v46, v47
    v_mfma_f32_32x32x16_bf16 v[32:47], v[104:107], v[96:99], 0
    s_nop 0
    v_mfma_f32_32x32x16_bf16 v[32:47], v[108:111], v[100:103], v[32:47]
    v_cvt_pk_bf16_f32 v112, v48, v49
    v_cvt_pk_bf16_f32 v113, v50, v51
    v_cvt_pk_bf16_f32 v114, v52, v53
    v_cvt_pk_bf16_f32 v115, v54, v55
    v_cvt_pk_bf16_f32 v116, v56, v57
    v_cvt_pk_bf16_f32 v117, v58, v59
    v_cvt_pk_bf16_f32 v118, v60, v61
    v_cvt_pk_bf16_f32 v119, v62, v63
    ds_write_b128 v29, v[112:115] offset:32768
    ds_write_b128 v29, v[116:119] offset:36864
    s_nop 1
    v_max3_f32 v96, v32, v33, v34
    v_max3_f32 v98, -v32, -v33, -v34
    v_max3_f32 v100, v40, v41, v42
    v_max3_f32 v102, -v40, -v41, -v42
    v_max3_f32 v96, v96, v35, v36
    v_max3_f32 v98, v98, -v35, -v36
    v_max3_f32 v100, v100, v43, v44
    v_max3_f32 v102, v102, -v43, -v44
    v_max3_f32 v96, v96, v37, v38
    v_max3_f32 v98, v98, -v37, -v38
    v_max3_f32 v100, v100, v45, v46
    v_max3_f32 v102, v102, -v45, -v46
    v_max_f32 v96, v96, v39
    v_max_f32_e64 v98, v98, -v39
    v_max_f32 v100, v100, v47
    v_max_f32_e64 v102, v102, -v47
    v_permlane32_swap_b32 v96, v98
    s_nop 0
    v_permlane32_swap_b32 v100, v102
    v_max_f32 v96, v96, v98
    v_max_f32 v100, v100, v102
    v_mul_f32 v96, s84, v96
    v_mul_f32 v100, s84, v100
    v_mov_b32 v98, v96
    v_mov_b32 v102, v100
    s_nop 0
    v_permlane32_swap_b32 v96, v98
    v_permlane32_swap_b32 v100, v102
    v_pk_fma_f32 v[48:49], v[32:33], s[0:1], v[96:97] op_sel_hi:[1,1,0] neg_lo:[0,0,1] neg_hi:[0,0,1]
    v_pk_fma_f32 v[56:57], v[32:33], s[0:1], v[98:99] op_sel_hi:[1,1,0] neg_lo:[1,0,1] neg_hi:[1,0,1]
    v_pk_fma_f32 v[50:51], v[34:35], s[0:1], v[96:97] op_sel_hi:[1,1,0] neg_lo:[0,0,1] neg_hi:[0,0,1]
    v_pk_fma_f32 v[58:59], v[34:35], s[0:1], v[98:99] op_sel_hi:[1,1,0] neg_lo:[1,0,1] neg_hi:[1,0,1]
    v_pk_fma_f32 v[52:53], v[36:37], s[0:1], v[96:97] op_sel_hi:[1,1,0] neg_lo:[0,0,1] neg_hi:[0,0,1]
    v_pk_fma_f32 v[60:61], v[36:37], s[0:1], v[98:99] op_sel_hi:[1,1,0] neg_lo:[1,0,1] neg_hi:[1,0,1]
    v_pk_fma_f32 v[54:55], v[38:39], s[0:1], v[96:97] op_sel_hi:[1,1,0] neg_lo:[0,0,1] neg_hi:[0,0,1]
    v_pk_fma_f32 v[62:63], v[38:39], s[0:1], v[98:99] op_sel_hi:[1,1,0] neg_lo:[1,0,1] neg_hi:[1,0,1]
    v_pk_fma_f32 v[112:113], v[40:41], s[0:1], v[100:101] op_sel_hi:[1,1,0] neg_lo:[0,0,1] neg_hi:[0,0,1]
    v_pk_fma_f32 v[120:121], v[40:41], s[0:1], v[102:103] op_sel_hi:[1,1,0] neg_lo:[1,0,1] neg_hi:[1,0,1]
    v_pk_fma_f32 v[114:115], v[42:43], s[0:1], v[100:101] op_sel_hi:[1,1,0] neg_lo:[0,0,1] neg_hi:[0,0,1]
    v_pk_fma_f32 v[122:123], v[42:43], s[0:1], v[102:103] op_sel_hi:[1,1,0] neg_lo:[1,0,1] neg_hi:[1,0,1]
    v_pk_fma_f32 v[116:117], v[44:45], s[0:1], v[100:101] op_sel_hi:[1,1,0] neg_lo:[0,0,1] neg_hi:[0,0,1]
    v_pk_fma_f32 v[124:125], v[44:45], s[0:1], v[102:103] op_sel_hi:[1,1,0] neg_lo:[1,0,1] neg_hi:[1,0,1]
    v_pk_fma_f32 v[118:119], v[46:47], s[0:1], v[100:101] op_sel_hi:[1,1,0] neg_lo:[0,0,1] neg_hi:[0,0,1]
    v_pk_fma_f32 v[126:127], v[46:47], s[0:1], v[102:103] op_sel_hi:[1,1,0] neg_lo:[1,0,1] neg_hi:[1,0,1]
    s_add_u32 s96, s15, 2
    s_cmp_ge_u32 s96, 5
    s_cselect_b32 s97, 5, 0
    s_sub_u32 s96, s96, s97
    s_lshl_b32 s97, s96, 13
    s_add_u32 s97, s97, s82
    s_lshl_b32 s96, s96, 16
    s_add_u32 s96, s96, s8
    s_add_u32 m0, s97, 8192
    s_nop 0
    buffer_load_dwordx4 v12, s[40:43], s96 offen lds
    v_exp_f32 v48, v48
    v_exp_f32 v49, v49
    v_exp_f32 v50, v50
    v_exp_f32 v51, v51
    v_exp_f32 v52, v52
    v_exp_f32 v53, v53
    v_exp_f32 v54, v54
    v_exp_f32 v55, v55
    v_exp_f32 v56, v56
    v_exp_f32 v57, v57
    v_exp_f32 v58, v58
    v_exp_f32 v59, v59
    v_exp_f32 v60, v60
    v_exp_f32 v61, v61
    v_exp_f32 v62, v62
    v_exp_f32 v63, v63
    s_add_u32 s96, s15, 3
    s_cmp_ge_u32 s96, 5
    s_cselect_b32 s97, 5, 0
    s_sub_u32 s96, s96, s97
    s_lshl_b32 s97, s96, 13
    s_add_u32 s97, s97, s82
    s_lshl_b32 s96, s96, 16
    s_add_u32 s96, s96, s8
    s_add_u32 m0, s97, 8192
    s_nop 0
    buffer_load_dwordx4 v12, s[40:43], s96 offen lds
    v_exp_f32 v112, v112
    v_exp_f32 v113, v113
    v_exp_f32 v114, v114
    v_exp_f32 v115, v115
    v_exp_f32 v116, v116
    v_exp_f32 v117, v117
    v_exp_f32 v118, v118
    v_exp_f32 v119, v119
    v_exp_f32 v120, v120
    v_exp_f32 v121, v121
    v_exp_f32 v122, v122
    v_exp_f32 v123, v123
    v_exp_f32 v124, v124
    v_exp_f32 v125, v125
    v_exp_f32 v126, v126
    v_exp_f32 v127, v127
    v_pk_add_f32 v[96:97], v[48:49], v[50:51]
    v_pk_add_f32 v[98:99], v[56:57], v[58:59]
    v_pk_add_f32 v[100:101], v[112:113], v[114:115]
    v_pk_add_f32 v[102:103], v[120:121], v[122:123]
    v_pk_add_f32 v[96:97], v[96:97], v[52:53]
    v_pk_add_f32 v[98:99], v[98:99], v[60:61]
    v_pk_add_f32 v[100:101], v[100:101], v[116:117]
    v_pk_add_f32 v[102:103], v[102:103], v[124:125]
    v_pk_add_f32 v[96:97], v[96:97], v[54:55]
    v_pk_add_f32 v[98:99], v[98:99], v[62:63]
    v_pk_add_f32 v[100:101], v[100:101], v[118:119]
    v_pk_add_f32 v[102:103], v[102:103], v[126:127]
    v_add_f32 v96, v96, v97
    v_add_f32 v98, v98, v99
    v_add_f32 v100, v100, v101
    v_add_f32 v102, v102, v103
    v_permlane32_swap_b32 v96, v98
    s_nop 0
    v_permlane32_swap_b32 v100, v102
    v_add_f32 v96, v96, v98
    v_add_f32 v100, v100, v102
    v_rcp_f32 v96, v96
    v_rcp_f32 v100, v100
    v_mov_b32 v98, v96
    v_mov_b32 v102, v100
    s_nop 0
    v_permlane32_swap_b32 v96, v98
    v_permlane32_swap_b32 v100, v102
    v_pk_mul_f32 v[48:49], v[48:49], v[96:97] op_sel_hi:[1,0]
    v_pk_mul_f32 v[50:51], v[50:51], v[96:97] op_sel_hi:[1,0]
    v_pk_mul_f32 v[52:53], v[52:53], v[96:97] op_sel_hi:[1,0]
    v_pk_mul_f32 v[54:55], v[54:55], v[96:97] op_sel_hi:[1,0]
    v_cvt_pk_bf16_f32 v32, v48, v49
    v_cvt_pk_bf16_f32 v33, v50, v51
    v_cvt_pk_bf16_f32 v34, v52, v53
    v_cvt_pk_bf16_f32 v35, v54, v55
    ds_write_b128 v28, v[32:35] offset:0
    v_pk_mul_f32 v[56:57], v[56:57], v[98:99] op_sel_hi:[1,0]
    v_pk_mul_f32 v[58:59], v[58:59], v[98:99] op_sel_hi:[1,0]
    v_pk_mul_f32 v[60:61], v[60:61], v[98:99] op_sel_hi:[1,0]
    v_pk_mul_f32 v[62:63], v[62:63], v[98:99] op_sel_hi:[1,0]
    v_cvt_pk_bf16_f32 v36, v56, v57
    v_cvt_pk_bf16_f32 v37, v58, v59
    v_cvt_pk_bf16_f32 v38, v60, v61
    v_cvt_pk_bf16_f32 v39, v62, v63
    ds_write_b128 v28, v[36:39] offset:4096
    v_pk_mul_f32 v[112:113], v[112:113], v[100:101] op_sel_hi:[1,0]
    v_pk_mul_f32 v[114:115], v[114:115], v[100:101] op_sel_hi:[1,0]
    v_pk_mul_f32 v[116:117], v[116:117], v[100:101] op_sel_hi:[1,0]
    v_pk_mul_f32 v[118:119], v[118:119], v[100:101] op_sel_hi:[1,0]
    v_cvt_pk_bf16_f32 v40, v112, v113
    v_cvt_pk_bf16_f32 v41, v114, v115
    v_cvt_pk_bf16_f32 v42, v116, v117
    v_cvt_pk_bf16_f32 v43, v118, v119
    ds_write_b128 v28, v[40:43] offset:8192
    v_pk_mul_f32 v[120:121], v[120:121], v[102:103] op_sel_hi:[1,0]
    v_pk_mul_f32 v[122:123], v[122:123], v[102:103] op_sel_hi:[1,0]
    v_pk_mul_f32 v[124:125], v[124:125], v[102:103] op_sel_hi:[1,0]
    v_pk_mul_f32 v[126:127], v[126:127], v[102:103] op_sel_hi:[1,0]
    v_cvt_pk_bf16_f32 v44, v120, v121
    v_cvt_pk_bf16_f32 v45, v122, v123
    v_cvt_pk_bf16_f32 v46, v124, v125
    v_cvt_pk_bf16_f32 v47, v126, v127
    ds_write_b128 v28, v[44:47] offset:12288
    s_lshl_b32 s88, s72, 12
    s_add_u32 s88, s88, 49152
    s_lshr_b32 s89, s72, 1
    s_lshl_b32 s89, s89, 12
    s_add_u32 s89, s89, 81920
    v_lshlrev_b32 v24, 3, v0
    v_add_u32 v25, s89, v24
    v_add_u32 v24, s88, v24
    v_mov_b32 v80, 0x3f803f80
    v_mov_b32 v81, 0x3f803f80
    v_mov_b32 v82, 0x3f803f80
    v_mov_b32 v83, 0x3f803f80
    s_lshl_b32 s88, s13, 4
    s_add_u32 s88, s88, s69
    s_lshl_b32 s88, s88, 3
    s_add_u32 s88, s88, s72
    s_lshl_b32 s89, s88, 10
    s_add_u32 s89, s89, 16777216
    s_lshl_b32 s90, s88, 6
    s_add_u32 s90, s90, 17825792
    v_and_b32 v27, 15, v0
    v_cmp_eq_u32 vcc, 0, v27
    v_mov_b32 v27, 2147483632
    s_nop 0
    v_cndmask_b32 v27, v27, v0, vcc
    s_mov_b32 s91, 0x07060501
    s_mov_b32 s92, 0x07060502
    s_mov_b32 s93, 0x07060503
    buffer_load_dword v31, off, s[64:67], s101 sc1
    s_waitcnt lgkmcnt(0)
    s_waitcnt vmcnt(3)
    s_barrier
    ds_read_b64_tr_b16 v[32:33], v24 offset:0
    ds_read_b64_tr_b16 v[34:35], v24 offset:512
    ds_read_b64_tr_b16 v[48:49], v25 offset:0
    ds_read_b64_tr_b16 v[50:51], v25 offset:512
    ds_read_b64_tr_b16 v[36:37], v24 offset:1024
    ds_read_b64_tr_b16 v[38:39], v24 offset:1536
    ds_read_b64_tr_b16 v[52:53], v25 offset:1024
    ds_read_b64_tr_b16 v[54:55], v25 offset:1536
    ds_read_b64_tr_b16 v[40:41], v24 offset:2048
    ds_read_b64_tr_b16 v[42:43], v24 offset:2560
    ds_read_b64_tr_b16 v[56:57], v25 offset:2048
    ds_read_b64_tr_b16 v[58:59], v25 offset:2560
    ds_read_b64_tr_b16 v[44:45], v24 offset:3072
    ds_read_b64_tr_b16 v[46:47], v24 offset:3584
    s_waitcnt lgkmcnt(10)
    ds_read_b64_tr_b16 v[60:61], v25 offset:3072
    ds_read_b64_tr_b16 v[62:63], v25 offset:3584
    v_mfma_f32_16x16x32_bf16 v[84:87], v[32:35], v[48:51], 0
    v_mfma_f32_16x16x32_bf16 v[88:91], v[32:35], v[80:83], 0
    s_waitcnt lgkmcnt(8)
    v_mfma_f32_16x16x32_bf16 v[84:87], v[36:39], v[52:55], v[84:87]
    v_mfma_f32_16x16x32_bf16 v[88:91], v[36:39], v[80:83], v[88:91]
    s_waitcnt lgkmcnt(4)
    v_mfma_f32_16x16x32_bf16 v[84:87], v[40:43], v[56:59], v[84:87]
    v_mfma_f32_16x16x32_bf16 v[88:91], v[40:43], v[80:83], v[88:91]
    s_waitcnt lgkmcnt(0)
    v_mfma_f32_16x16x32_bf16 v[84:87], v[44:47], v[60:63], v[84:87]
    v_mfma_f32_16x16x32_bf16 v[88:91], v[44:47], v[80:83], v[88:91]
    s_nop 6
    v_perm_b32 v84, v84, v87, s91
    v_perm_b32 v85, v85, v87, s92
    v_perm_b32 v86, v86, v87, s93
    v_mov_b32 v87, s76
    v_perm_b32 v88, v88, v91, s91
    v_perm_b32 v89, v89, v91, s92
    v_perm_b32 v90, v90, v91, s93
    v_mov_b32 v91, s76
    buffer_store_dwordx4 v[84:87], v22, s[48:51], s89 offen sc1
    buffer_store_dwordx4 v[88:91], v27, s[48:51], s90 offen sc1
    s_lshl_b32 s88, s2, 2
    s_add_u32 s88, s88, 18120704
    s_cmp_eq_u32 s72, 0
    s_cselect_b32 s88, s88, 2147483632
    v_mov_b32 v25, s76
    s_mov_b64 exec, 1
    buffer_store_dword v25, off, s[48:51], s88 sc1
    s_mov_b64 exec, -1
    s_cmp_eq_u32 s81, 1
    s_cbranch_scc1 L_kq
    s_barrier
    s_and_b32 s88, s70, 1
    s_xor_b32 s88, s88, 1
    s_lshl_b32 s89, s88, 6
    v_xor_b32 v11, s89, v11
    s_add_u32 s14, s14, s89
    s_lshl_b32 s86, s86, 13
    s_lshl_b32 s88, s88, 12
    s_add_u32 s86, s86, s88
    s_cmp_eq_u32 s74, 0
    s_cselect_b32 s86, s86, 0x40000000
    s_cselect_b32 s14, s14, 0x40000000
    s_cbranch_scc0 L_bb1_45
    ds_read_b64_tr_b16 v[80:81], v11 offset:0
    ds_read_b64_tr_b16 v[82:83], v11 offset:512
    ds_read_b64_tr_b16 v[84:85], v11 offset:2048
    ds_read_b64_tr_b16 v[86:87], v11 offset:2560
    ds_read_b64_tr_b16 v[88:89], v11 offset:4096
    ds_read_b64_tr_b16 v[90:91], v11 offset:4608
    s_waitcnt lgkmcnt(4)
    v_mfma_f32_32x32x16_bf16 v[64:79], v[80:83], a[0:3], 0
    ds_read_b64_tr_b16 v[92:93], v11 offset:6144
    ds_read_b64_tr_b16 v[94:95], v11 offset:6656
    s_waitcnt lgkmcnt(4)
    v_mfma_f32_32x32x16_bf16 v[64:79], v[84:87], a[4:7], v[64:79]
    ds_read_b64_tr_b16 v[80:81], v11 offset:8192
    ds_read_b64_tr_b16 v[82:83], v11 offset:8704
    s_add_u32 s96, s15, 4
    s_cmp_ge_u32 s96, 5
    s_cselect_b32 s97, 5, 0
    s_sub_u32 s96, s96, s97
    s_lshl_b32 s97, s96, 13
    s_add_u32 s97, s97, s82
    s_lshl_b32 s96, s96, 16
    s_add_u32 s96, s96, s8
    s_add_u32 m0, s97, 8192
    s_nop 0
    buffer_load_dwordx4 v12, s[40:43], s96 offen lds
    s_waitcnt lgkmcnt(4)
    v_mfma_f32_32x32x16_bf16 v[64:79], v[88:91], a[8:11], v[64:79]
    ds_read_b64_tr_b16 v[84:85], v11 offset:10240
    ds_read_b64_tr_b16 v[86:87], v11 offset:10752
    s_waitcnt lgkmcnt(4)
    v_mfma_f32_32x32x16_bf16 v[64:79], v[92:95], a[12:15], v[64:79]
    ds_read_b64_tr_b16 v[88:89], v11 offset:12288
    ds_read_b64_tr_b16 v[90:91], v11 offset:12800
    s_add_u32 s96, s15, 0
    s_add_u32 s96, s96, s15
    s_cmp_ge_u32 s96, 6
    s_cselect_b32 s97, 6, 0
    s_sub_u32 s96, s96, s97
    s_cmp_ge_u32 s96, 6
    s_cselect_b32 s97, 6, 0
    s_sub_u32 s96, s96, s97
    s_lshl_b32 s97, s96, 13
    s_add_u32 s97, s97, s82
    s_lshl_b32 s96, s96, 16
    s_add_u32 s96, s96, s8
    s_add_u32 s96, s96, 327680
    s_add_u32 m0, s97, 49152
    s_nop 0
    buffer_load_dwordx4 v12, s[40:43], s96 offen lds
    s_waitcnt lgkmcnt(4)
    v_mfma_f32_32x32x16_bf16 v[64:79], v[80:83], a[16:19], v[64:79]
    ds_read_b64_tr_b16 v[92:93], v11 offset:14336
    ds_read_b64_tr_b16 v[94:95], v11 offset:14848
    s_waitcnt lgkmcnt(4)
    v_mfma_f32_32x32x16_bf16 v[64:79], v[84:87], a[20:23], v[64:79]
    ds_read_b64_tr_b16 v[80:81], v11 offset:16384
    ds_read_b64_tr_b16 v[82:83], v11 offset:16896
    s_add_u32 s96, s15, 1
    s_add_u32 s96, s96, s15
    s_cmp_ge_u32 s96, 6
    s_cselect_b32 s97, 6, 0
    s_sub_u32 s96, s96, s97
    s_cmp_ge_u32 s96, 6
    s_cselect_b32 s97, 6, 0
    s_sub_u32 s96, s96, s97
    s_lshl_b32 s97, s96, 13
    s_add_u32 s97, s97, s82
    s_lshl_b32 s96, s96, 16
    s_add_u32 s96, s96, s8
    s_add_u32 s96, s96, 327680
    s_add_u32 m0, s97, 49152
    s_nop 0
    buffer_load_dwordx4 v12, s[40:43], s96 offen lds
    s_waitcnt lgkmcnt(4)
    v_mfma_f32_32x32x16_bf16 v[64:79], v[88:91], a[24:27], v[64:79]
    ds_read_b64_tr_b16 v[84:85], v11 offset:18432
    ds_read_b64_tr_b16 v[86:87], v11 offset:18944
    s_waitcnt lgkmcnt(4)
    v_mfma_f32_32x32x16_bf16 v[64:79], v[92:95], a[28:31], v[64:79]
    ds_read_b64_tr_b16 v[88:89], v11 offset:20480
    ds_read_b64_tr_b16 v[90:91], v11 offset:20992
    s_add_u32 s96, s15, 2
    s_add_u32 s96, s96, s15
    s_cmp_ge_u32 s96, 6
    s_cselect_b32 s97, 6, 0
    s_sub_u32 s96, s96, s97
    s_cmp_ge_u32 s96, 6
    s_cselect_b32 s97, 6, 0
    s_sub_u32 s96, s96, s97
    s_lshl_b32 s97, s96, 13
    s_add_u32 s97, s97, s82
    s_lshl_b32 s96, s96, 16
    s_add_u32 s96, s96, s8
    s_add_u32 s96, s96, 327680
    s_add_u32 m0, s97, 49152
    s_nop 0
    buffer_load_dwordx4 v12, s[40:43], s96 offen lds
    s_waitcnt lgkmcnt(4)
    v_mfma_f32_32x32x16_bf16 v[64:79], v[80:83], a[32:35], v[64:79]
    ds_read_b64_tr_b16 v[92:93], v11 offset:22528
    ds_read_b64_tr_b16 v[94:95], v11 offset:23040
    s_waitcnt lgkmcnt(4)
    v_mfma_f32_32x32x16_bf16 v[64:79], v[84:87], a[36:39], v[64:79]
    ds_read_b64_tr_b16 v[80:81], v11 offset:24576
    ds_read_b64_tr_b16 v[82:83], v11 offset:25088
    s_add_u32 s96, s15, 3
    s_add_u32 s96, s96, s15
    s_cmp_ge_u32 s96, 6
    s_cselect_b32 s97, 6, 0
    s_sub_u32 s96, s96, s97
    s_cmp_ge_u32 s96, 6
    s_cselect_b32 s97, 6, 0
    s_sub_u32 s96, s96, s97
    s_lshl_b32 s97, s96, 13
    s_add_u32 s97, s97, s82
    s_lshl_b32 s96, s96, 16
    s_add_u32 s96, s96, s8
    s_add_u32 s96, s96, 327680
    s_add_u32 m0, s97, 49152
    s_nop 0
    buffer_load_dwordx4 v12, s[40:43], s96 offen lds
    s_waitcnt lgkmcnt(4)
    v_mfma_f32_32x32x16_bf16 v[64:79], v[88:91], a[40:43], v[64:79]
    ds_read_b64_tr_b16 v[84:85], v11 offset:26624
    ds_read_b64_tr_b16 v[86:87], v11 offset:27136
    s_waitcnt lgkmcnt(4)
    v_mfma_f32_32x32x16_bf16 v[64:79], v[92:95], a[44:47], v[64:79]
    ds_read_b64_tr_b16 v[88:89], v11 offset:28672
    ds_read_b64_tr_b16 v[90:91], v11 offset:29184
    s_add_u32 s96, s15, 4
    s_add_u32 s96, s96, s15
    s_cmp_ge_u32 s96, 6
    s_cselect_b32 s97, 6, 0
    s_sub_u32 s96, s96, s97
    s_cmp_ge_u32 s96, 6
    s_cselect_b32 s97, 6, 0
    s_sub_u32 s96, s96, s97
    s_lshl_b32 s97, s96, 13
    s_add_u32 s97, s97, s82
    s_lshl_b32 s96, s96, 16
    s_add_u32 s96, s96, s8
    s_add_u32 s96, s96, 327680
    s_add_u32 m0, s97, 49152
    s_nop 0
    buffer_load_dwordx4 v12, s[40:43], s96 offen lds
    s_waitcnt lgkmcnt(4)
    v_mfma_f32_32x32x16_bf16 v[64:79], v[80:83], a[48:51], v[64:79]
    ds_read_b64_tr_b16 v[92:93], v11 offset:30720
    ds_read_b64_tr_b16 v[94:95], v11 offset:31232
    s_waitcnt lgkmcnt(4)
    v_mfma_f32_32x32x16_bf16 v[64:79], v[84:87], a[52:55], v[64:79]
    s_add_u32 s96, s15, 5
    s_add_u32 s96, s96, s15
    s_cmp_ge_u32 s96, 6
    s_cselect_b32 s97, 6, 0
    s_sub_u32 s96, s96, s97
    s_cmp_ge_u32 s96, 6
    s_cselect_b32 s97, 6, 0
    s_sub_u32 s96, s96, s97
    s_lshl_b32 s97, s96, 13
    s_add_u32 s97, s97, s82
    s_lshl_b32 s96, s96, 16
    s_add_u32 s96, s96, s8
    s_add_u32 s96, s96, 327680
    s_add_u32 m0, s97, 49152
    s_nop 0
    buffer_load_dwordx4 v12, s[40:43], s96 offen lds
    s_waitcnt lgkmcnt(2)
    v_mfma_f32_32x32x16_bf16 v[64:79], v[88:91], a[56:59], v[64:79]
    s_waitcnt lgkmcnt(0)
    v_mfma_f32_32x32x16_bf16 v[64:79], v[92:95], a[60:63], v[64:79]
    ds_read_b64_tr_b16 v[80:81], v11 offset:32768
    ds_read_b64_tr_b16 v[82:83], v11 offset:33280
    ds_read_b64_tr_b16 v[84:85], v11 offset:34816
    ds_read_b64_tr_b16 v[86:87], v11 offset:35328
    ds_read_b64_tr_b16 v[88:89], v11 offset:36864
    ds_read_b64_tr_b16 v[90:91], v11 offset:37376
    s_waitcnt lgkmcnt(4)
    v_mfma_f32_32x32x16_bf16 v[64:79], v[80:83], a[64:67], v[64:79]
    ds_read_b64_tr_b16 v[92:93], v11 offset:38912
    ds_read_b64_tr_b16 v[94:95], v11 offset:39424
    s_waitcnt lgkmcnt(4)
    v_mfma_f32_32x32x16_bf16 v[64:79], v[84:87], a[68:71], v[64:79]
    ds_read_b64_tr_b16 v[80:81], v11 offset:40960
    ds_read_b64_tr_b16 v[82:83], v11 offset:41472
    s_waitcnt lgkmcnt(4)
    v_mfma_f32_32x32x16_bf16 v[64:79], v[88:91], a[72:75], v[64:79]
    ds_read_b64_tr_b16 v[84:85], v11 offset:43008
    ds_read_b64_tr_b16 v[86:87], v11 offset:43520
    s_waitcnt lgkmcnt(4)
    v_mfma_f32_32x32x16_bf16 v[64:79], v[92:95], a[76:79], v[64:79]
    ds_read_b64_tr_b16 v[88:89], v11 offset:45056
    ds_read_b64_tr_b16 v[90:91], v11 offset:45568
    s_waitcnt lgkmcnt(4)
    v_mfma_f32_32x32x16_bf16 v[64:79], v[80:83], a[80:83], v[64:79]
    ds_read_b64_tr_b16 v[92:93], v11 offset:47104
    ds_read_b64_tr_b16 v[94:95], v11 offset:47616
    s_waitcnt lgkmcnt(4)
    v_mfma_f32_32x32x16_bf16 v[64:79], v[84:87], a[84:87], v[64:79]
    ds_read_b64_tr_b16 v[80:81], v11 offset:49152
    ds_read_b64_tr_b16 v[82:83], v11 offset:49664
    s_waitcnt lgkmcnt(4)
    v_mfma_f32_32x32x16_bf16 v[64:79], v[88:91], a[88:91], v[64:79]
    ds_read_b64_tr_b16 v[84:85], v11 offset:51200
    ds_read_b64_tr_b16 v[86:87], v11 offset:51712
    s_waitcnt lgkmcnt(4)
    v_mfma_f32_32x32x16_bf16 v[64:79], v[92:95], a[92:95], v[64:79]
    ds_read_b64_tr_b16 v[88:89], v11 offset:53248
    ds_read_b64_tr_b16 v[90:91], v11 offset:53760
    s_waitcnt lgkmcnt(4)
    v_mfma_f32_32x32x16_bf16 v[64:79], v[80:83], a[96:99], v[64:79]
    ds_read_b64_tr_b16 v[92:93], v11 offset:55296
    ds_read_b64_tr_b16 v[94:95], v11 offset:55808
    s_waitcnt lgkmcnt(4)
    v_mfma_f32_32x32x16_bf16 v[64:79], v[84:87], a[100:103], v[64:79]
    ds_read_b64_tr_b16 v[80:81], v11 offset:57344
    ds_read_b64_tr_b16 v[82:83], v11 offset:57856
    s_waitcnt lgkmcnt(4)
    v_mfma_f32_32x32x16_bf16 v[64:79], v[88:91], a[104:107], v[64:79]
    ds_read_b64_tr_b16 v[84:85], v11 offset:59392
    ds_read_b64_tr_b16 v[86:87], v11 offset:59904
    s_waitcnt lgkmcnt(4)
    v_mfma_f32_32x32x16_bf16 v[64:79], v[92:95], a[108:111], v[64:79]
    ds_read_b64_tr_b16 v[88:89], v11 offset:61440
    ds_read_b64_tr_b16 v[90:91], v11 offset:61952
    s_waitcnt lgkmcnt(4)
    v_mfma_f32_32x32x16_bf16 v[64:79], v[80:83], a[112:115], v[64:79]
    ds_read_b64_tr_b16 v[92:93], v11 offset:63488
    ds_read_b64_tr_b16 v[94:95], v11 offset:64000
    s_waitcnt lgkmcnt(4)
    v_mfma_f32_32x32x16_bf16 v[64:79], v[84:87], a[116:119], v[64:79]
    s_waitcnt lgkmcnt(2)
    v_mfma_f32_32x32x16_bf16 v[64:79], v[88:91], a[120:123], v[64:79]
    s_waitcnt lgkmcnt(0)
    v_mfma_f32_32x32x16_bf16 v[64:79], v[92:95], a[124:127], v[64:79]
    s_nop 11
    v_max_f32 v64, 0, v64
    v_max_f32 v65, 0, v65
    v_cvt_pk_bf16_f32 v80, v64, v65
    v_max_f32 v66, 0, v66
    v_max_f32 v67, 0, v67
    v_cvt_pk_bf16_f32 v81, v66, v67
    v_max_f32 v68, 0, v68
    v_max_f32 v69, 0, v69
    v_cvt_pk_bf16_f32 v82, v68, v69
    v_max_f32 v70, 0, v70
    v_max_f32 v71, 0, v71
    v_cvt_pk_bf16_f32 v83, v70, v71
    v_max_f32 v72, 0, v72
    v_max_f32 v73, 0, v73
    v_cvt_pk_bf16_f32 v84, v72, v73
    v_max_f32 v74, 0, v74
    v_max_f32 v75, 0, v75
    v_cvt_pk_bf16_f32 v85, v74, v75
    v_max_f32 v76, 0, v76
    v_max_f32 v77, 0, v77
    v_cvt_pk_bf16_f32 v86, v76, v77
    v_max_f32 v78, 0, v78
    v_max_f32 v79, 0, v79
    v_cvt_pk_bf16_f32 v87, v78, v79
    s_branch L_bbd_46
L_bb1_45:
    s_add_u32 s96, s15, 4
    s_cmp_ge_u32 s96, 5
    s_cselect_b32 s97, 5, 0
    s_sub_u32 s96, s96, s97
    s_lshl_b32 s97, s96, 13
    s_add_u32 s97, s97, s82
    s_lshl_b32 s96, s96, 16
    s_add_u32 s96, s96, s8
    s_add_u32 m0, s97, 8192
    s_nop 0
    buffer_load_dwordx4 v12, s[40:43], s96 offen lds
    s_add_u32 s96, s15, 0
    s_add_u32 s96, s96, s15
    s_cmp_ge_u32 s96, 6
    s_cselect_b32 s97, 6, 0
    s_sub_u32 s96, s96, s97
    s_cmp_ge_u32 s96, 6
    s_cselect_b32 s97, 6, 0
    s_sub_u32 s96, s96, s97
    s_lshl_b32 s97, s96, 13
    s_add_u32 s97, s97, s82
    s_lshl_b32 s96, s96, 16
    s_add_u32 s96, s96, s8
    s_add_u32 s96, s96, 327680
    s_add_u32 m0, s97, 49152
    s_nop 0
    buffer_load_dwordx4 v12, s[40:43], s96 offen lds
    s_add_u32 s96, s15, 1
    s_add_u32 s96, s96, s15
    s_cmp_ge_u32 s96, 6
    s_cselect_b32 s97, 6, 0
    s_sub_u32 s96, s96, s97
    s_cmp_ge_u32 s96, 6
    s_cselect_b32 s97, 6, 0
    s_sub_u32 s96, s96, s97
    s_lshl_b32 s97, s96, 13
    s_add_u32 s97, s97, s82
    s_lshl_b32 s96, s96, 16
    s_add_u32 s96, s96, s8
    s_add_u32 s96, s96, 327680
    s_add_u32 m0, s97, 49152
    s_nop 0
    buffer_load_dwordx4 v12, s[40:43], s96 offen lds
    s_add_u32 s96, s15, 2
    s_add_u32 s96, s96, s15
    s_cmp_ge_u32 s96, 6
    s_cselect_b32 s97, 6, 0
    s_sub_u32 s96, s96, s97
    s_cmp_ge_u32 s96, 6
    s_cselect_b32 s97, 6, 0
    s_sub_u32 s96, s96, s97
    s_lshl_b32 s97, s96, 13
    s_add_u32 s97, s97, s82
    s_lshl_b32 s96, s96, 16
    s_add_u32 s96, s96, s8
    s_add_u32 s96, s96, 327680
    s_add_u32 m0, s97, 49152
    s_nop 0
    buffer_load_dwordx4 v12, s[40:43], s96 offen lds
    s_add_u32 s96, s15, 3
    s_add_u32 s96, s96, s15
    s_cmp_ge_u32 s96, 6
    s_cselect_b32 s97, 6, 0
    s_sub_u32 s96, s96, s97
    s_cmp_ge_u32 s96, 6
    s_cselect_b32 s97, 6, 0
    s_sub_u32 s96, s96, s97
    s_lshl_b32 s97, s96, 13
    s_add_u32 s97, s97, s82
    s_lshl_b32 s96, s96, 16
    s_add_u32 s96, s96, s8
    s_add_u32 s96, s96, 327680
    s_add_u32 m0, s97, 49152
    s_nop 0
    buffer_load_dwordx4 v12, s[40:43], s96 offen lds
    s_add_u32 s96, s15, 4
    s_add_u32 s96, s96, s15
    s_cmp_ge_u32 s96, 6
    s_cselect_b32 s97, 6, 0
    s_sub_u32 s96, s96, s97
    s_cmp_ge_u32 s96, 6
    s_cselect_b32 s97, 6, 0
    s_sub_u32 s96, s96, s97
    s_lshl_b32 s97, s96, 13
    s_add_u32 s97, s97, s82
    s_lshl_b32 s96, s96, 16
    s_add_u32 s96, s96, s8
    s_add_u32 s96, s96, 327680
    s_add_u32 m0, s97, 49152
    s_nop 0
    buffer_load_dwordx4 v12, s[40:43], s96 offen lds
    s_add_u32 s96, s15, 5
    s_add_u32 s96, s96, s15
    s_cmp_ge_u32 s96, 6
    s_cselect_b32 s97, 6, 0
    s_sub_u32 s96, s96, s97
    s_cmp_ge_u32 s96, 6
    s_cselect_b32 s97, 6, 0
    s_sub_u32 s96, s96, s97
    s_lshl_b32 s97, s96, 13
    s_add_u32 s97, s97, s82
    s_lshl_b32 s96, s96, 16
    s_add_u32 s96, s96, s8
    s_add_u32 s96, s96, 327680
    s_add_u32 m0, s97, 49152
    s_nop 0
    buffer_load_dwordx4 v12, s[40:43], s96 offen lds
    s_cmp_eq_u32 s70, 11
    s_cbranch_scc0 L_bbd_46
    v_lshrrev_b32 v24, 5, v0
    v_lshlrev_b32 v24, 4, v24
    v_lshrrev_b32 v25, 2, v0
    v_lshrrev_b32 v26, 4, v0
    v_xor_b32 v25, v25, v26
    v_and_b32 v25, 1, v25
    v_lshl_add_u32 v24, v25, 10, v24
    ds_read_b128 v[80:83], v24 offset:0
    ds_read_b128 v[84:87], v24 offset:32
    ds_read_b128 v[88:91], v24 offset:64
    ds_read_b128 v[92:95], v24 offset:96
    ds_read_b128 v[96:99], v24 offset:128
    ds_read_b128 v[100:103], v24 offset:160
    s_waitcnt lgkmcnt(5)
    v_mfma_f32_16x16x32_bf16 v[32:35], v[80:83], a[0:3], 0
    ds_read_b128 v[80:83], v24 offset:192
    s_waitcnt lgkmcnt(5)
    v_mfma_f32_16x16x32_bf16 v[32:35], v[84:87], a[4:7], v[32:35]
    ds_read_b128 v[84:87], v24 offset:224
    s_waitcnt lgkmcnt(5)
    v_mfma_f32_16x16x32_bf16 v[32:35], v[88:91], a[8:11], v[32:35]
    ds_read_b128 v[88:91], v24 offset:256
    s_waitcnt lgkmcnt(5)
    v_mfma_f32_16x16x32_bf16 v[32:35], v[92:95], a[12:15], v[32:35]
    ds_read_b128 v[92:95], v24 offset:288
    s_waitcnt lgkmcnt(5)
    v_mfma_f32_16x16x32_bf16 v[32:35], v[96:99], a[16:19], v[32:35]
    ds_read_b128 v[96:99], v24 offset:320
    s_waitcnt lgkmcnt(5)
    v_mfma_f32_16x16x32_bf16 v[32:35], v[100:103], a[20:23], v[32:35]
    ds_read_b128 v[100:103], v24 offset:352
    s_waitcnt lgkmcnt(5)
    v_mfma_f32_16x16x32_bf16 v[32:35], v[80:83], a[24:27], v[32:35]
    ds_read_b128 v[80:83], v24 offset:384
    s_waitcnt lgkmcnt(5)
    v_mfma_f32_16x16x32_bf16 v[32:35], v[84:87], a[28:31], v[32:35]
    ds_read_b128 v[84:87], v24 offset:416
    s_waitcnt lgkmcnt(5)
    v_mfma_f32_16x16x32_bf16 v[32:35], v[88:91], a[32:35], v[32:35]
    ds_read_b128 v[88:91], v24 offset:448
    s_waitcnt lgkmcnt(5)
    v_mfma_f32_16x16x32_bf16 v[32:35], v[92:95], a[36:39], v[32:35]
    ds_read_b128 v[92:95], v24 offset:480
    s_waitcnt lgkmcnt(5)
    v_mfma_f32_16x16x32_bf16 v[32:35], v[96:99], a[40:43], v[32:35]
    ds_read_b128 v[96:99], v24 offset:512
    s_waitcnt lgkmcnt(5)
    v_mfma_f32_16x16x32_bf16 v[32:35], v[100:103], a[44:47], v[32:35]
    ds_read_b128 v[100:103], v24 offset:544
    s_waitcnt lgkmcnt(5)
    v_mfma_f32_16x16x32_bf16 v[32:35], v[80:83], a[48:51], v[32:35]
    ds_read_b128 v[80:83], v24 offset:576
    s_waitcnt lgkmcnt(5)
    v_mfma_f32_16x16x32_bf16 v[32:35], v[84:87], a[52:55], v[32:35]
    ds_read_b128 v[84:87], v24 offset:608
    s_waitcnt lgkmcnt(5)
    v_mfma_f32_16x16x32_bf16 v[32:35], v[88:91], a[56:59], v[32:35]
    ds_read_b128 v[88:91], v24 offset:640
    s_waitcnt lgkmcnt(5)
    v_mfma_f32_16x16x32_bf16 v[32:35], v[92:95], a[60:63], v[32:35]
    ds_read_b128 v[92:95], v24 offset:672
    s_waitcnt lgkmcnt(5)
    v_mfma_f32_16x16x32_bf16 v[32:35], v[96:99], a[64:67], v[32:35]
    ds_read_b128 v[96:99], v24 offset:704
    s_waitcnt lgkmcnt(5)
    v_mfma_f32_16x16x32_bf16 v[32:35], v[100:103], a[68:71], v[32:35]
    ds_read_b128 v[100:103], v24 offset:736
    s_waitcnt lgkmcnt(5)
    v_mfma_f32_16x16x32_bf16 v[32:35], v[80:83], a[72:75], v[32:35]
    ds_read_b128 v[80:83], v24 offset:768
    s_waitcnt lgkmcnt(5)
    v_mfma_f32_16x16x32_bf16 v[32:35], v[84:87], a[76:79], v[32:35]
    ds_read_b128 v[84:87], v24 offset:800
    s_waitcnt lgkmcnt(5)
    v_mfma_f32_16x16x32_bf16 v[32:35], v[88:91], a[80:83], v[32:35]
    ds_read_b128 v[88:91], v24 offset:832
    s_waitcnt lgkmcnt(5)
    v_mfma_f32_16x16x32_bf16 v[32:35], v[92:95], a[84:87], v[32:35]
    ds_read_b128 v[92:95], v24 offset:864
    s_waitcnt lgkmcnt(5)
    v_mfma_f32_16x16x32_bf16 v[32:35], v[96:99], a[88:91], v[32:35]
    ds_read_b128 v[96:99], v24 offset:896
    s_waitcnt lgkmcnt(5)
    v_mfma_f32_16x16x32_bf16 v[32:35], v[100:103], a[92:95], v[32:35]
    ds_read_b128 v[100:103], v24 offset:928
    s_waitcnt lgkmcnt(5)
    v_mfma_f32_16x16x32_bf16 v[32:35], v[80:83], a[96:99], v[32:35]
    ds_read_b128 v[80:83], v24 offset:960
    s_waitcnt lgkmcnt(5)
    v_mfma_f32_16x16x32_bf16 v[32:35], v[84:87], a[100:103], v[32:35]
    ds_read_b128 v[84:87], v24 offset:992
    s_waitcnt lgkmcnt(5)
    v_mfma_f32_16x16x32_bf16 v[32:35], v[88:91], a[104:107], v[32:35]
    s_waitcnt lgkmcnt(4)
    v_mfma_f32_16x16x32_bf16 v[32:35], v[92:95], a[108:111], v[32:35]
    s_waitcnt lgkmcnt(3)
    v_mfma_f32_16x16x32_bf16 v[32:35], v[96:99], a[112:115], v[32:35]
    s_waitcnt lgkmcnt(2)
    v_mfma_f32_16x16x32_bf16 v[32:35], v[100:103], a[116:119], v[32:35]
    s_waitcnt lgkmcnt(1)
    v_mfma_f32_16x16x32_bf16 v[32:35], v[80:83], a[120:123], v[32:35]
    s_waitcnt lgkmcnt(0)
    v_mfma_f32_16x16x32_bf16 v[32:35], v[84:87], a[124:127], v[32:35]
    s_lshl_b32 s90, s69, 2
    s_add_u32 s90, s90, s73
    s_lshl_b32 s90, s90, 8
    s_add_u32 s90, s90, 17891328
    v_and_b32 v25, 31, v0
    v_lshlrev_b32 v25, 3, v25
    v_mov_b32 v27, s76
    s_nop 0
    v_mul_f32 v26, s84, v32
    v_exp_f32_e64 v26, -v26
    s_nop 0
    v_add_f32 v26, 1.0, v26
    v_rcp_f32 v26, v26
    s_nop 0
    buffer_store_dwordx2 v[26:27], v25, s[48:51], s90 offen sc1
L_bbd_46:
    s_waitcnt vmcnt(10)
    s_mov_b32 s94, 40000
L_gm_48:
    v_readfirstlane_b32 s89, v31
    s_nop 1
    s_and_b32 s90, s89, 31
    s_cselect_b32 s90, 0, s89
    s_cmp_lg_u32 s90, 0
    s_cbranch_scc1 L_gmd_49
    s_sub_u32 s94, s94, 1
    s_cbranch_scc1 L_gmd_49
    s_lshl_b32 s88, s68, 5
    buffer_load_dword v31, off, s[64:67], s88 sc1
    s_waitcnt vmcnt(0)
    s_branch L_gm_48
L_gmd_49:
    s_mul_i32 s90, s95, s95
    s_lshl_b32 s90, s90, 16
    s_lshl_b32 s91, s95, 8
    s_add_u32 s90, s90, s91
    s_add_u32 s90, s90, 1
    s_lshl_b32 s90, s90, 5
    s_cmp_eq_u32 s89, s90
    s_cselect_b32 s77, 1, 0
    buffer_load_dword v24, v21, s[48:51], 0 offen sc1
    s_barrier
    s_bfe_u32 s89, s72, 0x10001
    s_lshl_b32 s90, s74, 1
    s_sub_u32 s90, s89, s90
    s_lshl_b32 s90, s90, 11
    s_lshl_b32 s89, s89, 6
    v_add_u32 v10, s90, v13
    v_xor_b32 v10, s89, v10
    v_xor_b32 v11, 64, v10
    s_xor_b32 s89, s15, s74
    s_and_b32 s89, s89, 1
    s_lshl_b32 s91, s89, 19
    s_lshl_b32 s89, s89, 8
    v_add_u32 v9, s90, v19
    v_xor_b32 v9, s91, v9
    v_lshrrev_b32 v25, 3, v0
    v_cmp_eq_u32 vcc, 3, v25
    v_xor_b32 v25, s89, v9
    s_nop 0
    v_cndmask_b32 v9, v9, v25, vcc
    s_waitcnt vmcnt(0)
    s_mov_b32 s94, 40000
L_pf_50:
    v_cmp_ne_u32 vcc, s76, v24
    s_nop 1
    s_and_b32 s88, vcc_lo, 0x7001f
    s_cbranch_scc0 L_pfd_51
    s_sub_u32 s94, s94, 1
    s_cbranch_scc1 L_pfd_51
    buffer_load_dword v24, v21, s[48:51], 0 offen sc1
    s_waitcnt vmcnt(0)
    s_branch L_pf_50
L_pfd_51:
    s_add_u32 s80, s5, 0
    s_cmp_ge_u32 s80, 5
    s_cselect_b32 s100, 5, 0
    s_sub_u32 s80, s80, s100
    s_lshl_b32 s80, s80, 13
    s_add_u32 s80, s80, s6
    buffer_load_dwordx4 a[0:3], v9, s[48:51], s80 offen offset:0 sc1
    s_add_u32 s80, s5, 0
    s_cmp_ge_u32 s80, 5
    s_cselect_b32 s100, 5, 0
    s_sub_u32 s80, s80, s100
    s_lshl_b32 s80, s80, 13
    s_add_u32 s80, s80, s6
    buffer_load_dwordx4 a[4:7], v9, s[48:51], s80 offen offset:2048 sc1
    s_add_u32 s80, s5, 1
    s_cmp_ge_u32 s80, 5
    s_cselect_b32 s100, 5, 0
    s_sub_u32 s80, s80, s100
    s_lshl_b32 s80, s80, 13
    s_add_u32 s80, s80, s6
    buffer_load_dwordx4 a[8:11], v9, s[48:51], s80 offen offset:0 sc1
    s_add_u32 s80, s5, 1
    s_cmp_ge_u32 s80, 5
    s_cselect_b32 s100, 5, 0
    s_sub_u32 s80, s80, s100
    s_lshl_b32 s80, s80, 13
    s_add_u32 s80, s80, s6
    buffer_load_dwordx4 a[12:15], v9, s[48:51], s80 offen offset:2048 sc1
    s_add_u32 s80, s5, 2
    s_cmp_ge_u32 s80, 5
    s_cselect_b32 s100, 5, 0
    s_sub_u32 s80, s80, s100
    s_lshl_b32 s80, s80, 13
    s_add_u32 s80, s80, s6
    buffer_load_dwordx4 a[16:19], v9, s[48:51], s80 offen offset:0 sc1
    s_add_u32 s80, s5, 2
    s_cmp_ge_u32 s80, 5
    s_cselect_b32 s100, 5, 0
    s_sub_u32 s80, s80, s100
    s_lshl_b32 s80, s80, 13
    s_add_u32 s80, s80, s6
    buffer_load_dwordx4 a[20:23], v9, s[48:51], s80 offen offset:2048 sc1
    s_mov_b32 s17, s86
    s_add_u32 s91, s86, 2048
    buffer_store_dwordx4 v[80:83], v20, s[48:51], s86 offen sc1
    buffer_store_dwordx4 v[84:87], v20, s[48:51], s91 offen sc1
    v_and_b32 v1, 31, v0
    v_lshrrev_b32 v25, 5, v0
    v_lshlrev_b32 v25, 1, v25
    v_and_b32 v26, 7, v0
    v_xor_b32 v25, v25, v26
    v_lshlrev_b32 v25, 4, v25
    v_lshl_add_u32 v1, v1, 8, v25
    s_and_b32 s92, s72, 1
    s_lshl_b32 s92, s92, 15
    s_lshr_b32 s89, s72, 1
    s_lshl_b32 s90, s89, 13
    s_add_u32 s90, s90, s92
    s_add_u32 s90, s90, 8192
    v_add_u32 v1, s90, v1
    v_xor_b32 v2, 16, v1
    v_xor_b32 v3, 64, v1
    v_xor_b32 v4, 0x50, v1
    v_lshrrev_b32 v27, 3, v0
    v_lshlrev_b32 v5, 1, v26
    v_xor_b32 v5, v5, v27
    v_lshlrev_b32 v5, 4, v5
    v_lshl_add_u32 v5, v27, 8, v5
    s_lshl_b32 s90, s89, 11
    s_add_u32 s90, s90, s92
    s_add_u32 s90, s90, 8192
    v_add_u32 v5, s90, v5
    v_xor_b32 v6, 16, v5
    s_lshl_b32 s90, s68, 8
    s_lshl_b32 s91, s15, 6
    s_add_u32 s90, s90, s91
    s_lshr_b32 s91, s92, 10
    s_add_u32 s90, s90, s91
    s_lshl_b32 s85, s90, 3
    s_add_u32 s85, s85, 17891328
    s_lshl_b32 s91, s89, 3
    s_add_u32 s90, s90, s91
    s_lshl_b32 s90, s90, 10
    s_lshl_b32 s91, s3, 7
    s_add_u32 s90, s90, s91
    v_lshlrev_b32 v26, 4, v26
    v_lshl_add_u32 v7, v27, 10, v26
    v_add_u32 v7, s90, v7
    s_lshl_b32 s90, s68, 2
    s_add_u32 s90, s90, s15
    s_lshl_b32 s90, s90, 3
    s_add_u32 s90, s90, s3
    s_lshl_b32 s90, s90, 14
    s_lshr_b32 s91, s92, 3
    s_add_u32 s90, s90, s91
    s_add_u32 s86, s90, 20971520
    s_barrier
    s_add_u32 s96, s5, 0
    s_cmp_ge_u32 s96, 5
    s_cselect_b32 s100, 5, 0
    s_sub_u32 s96, s96, s100
    s_lshl_b32 s96, s96, 13
    v_add_u32 v15, s96, v10
    v_add_u32 v16, s96, v11
    ds_read_b64_tr_b16 v[96:97], v15 offset:8192
    ds_read_b64_tr_b16 v[98:99], v15 offset:8704
    ds_read_b64_tr_b16 v[100:101], v16 offset:8192
    ds_read_b64_tr_b16 v[102:103], v16 offset:8704
    ds_read_b64_tr_b16 v[104:105], v15 offset:10240
    ds_read_b64_tr_b16 v[106:107], v15 offset:10752
    ds_read_b64_tr_b16 v[108:109], v16 offset:10240
    ds_read_b64_tr_b16 v[110:111], v16 offset:10752
    s_add_u32 s80, s5, 3
    s_cmp_ge_u32 s80, 5
    s_cselect_b32 s100, 5, 0
    s_sub_u32 s80, s80, s100
    s_lshl_b32 s80, s80, 13
    s_add_u32 s80, s80, s6
    buffer_load_dwordx4 a[24:27], v9, s[48:51], s80 offen offset:0 sc1
    s_add_u32 s96, s5, 1
    s_cmp_ge_u32 s96, 5
    s_cselect_b32 s100, 5, 0
    s_sub_u32 s96, s96, s100
    s_lshl_b32 s96, s96, 13
    v_add_u32 v15, s96, v10
    v_add_u32 v16, s96, v11
    ds_read_b64_tr_b16 a[120:121], v15 offset:8192
    ds_read_b64_tr_b16 a[122:123], v15 offset:8704
    ds_read_b64_tr_b16 a[124:125], v16 offset:8192
    ds_read_b64_tr_b16 a[126:127], v16 offset:8704
    s_waitcnt vmcnt(8) lgkmcnt(8)
    v_mfma_f32_32x32x16_bf16 v[64:79], v[96:99], a[0:3], 0
    v_mfma_f32_32x32x16_bf16 v[80:95], v[100:103], a[0:3], 0
    s_add_u32 s80, s5, 3
    s_cmp_ge_u32 s80, 5
    s_cselect_b32 s100, 5, 0
    s_sub_u32 s80, s80, s100
    s_lshl_b32 s80, s80, 13
    s_add_u32 s80, s80, s6
    buffer_load_dwordx4 a[28:31], v9, s[48:51], s80 offen offset:2048 sc1
    ds_read_b64_tr_b16 v[96:97], v15 offset:10240
    ds_read_b64_tr_b16 v[98:99], v15 offset:10752
    ds_read_b64_tr_b16 v[100:101], v16 offset:10240
    ds_read_b64_tr_b16 v[102:103], v16 offset:10752
    s_waitcnt vmcnt(8) lgkmcnt(8)
    v_mfma_f32_32x32x16_bf16 v[64:79], v[104:107], a[4:7], v[64:79]
    v_mfma_f32_32x32x16_bf16 v[80:95], v[108:111], a[4:7], v[80:95]
    s_add_u32 s80, s5, 4
    s_cmp_ge_u32 s80, 5
    s_cselect_b32 s100, 5, 0
    s_sub_u32 s80, s80, s100
    s_lshl_b32 s80, s80, 13
    s_add_u32 s80, s80, s6
    buffer_load_dwordx4 a[32:35], v9, s[48:51], s80 offen offset:0 sc1
    s_add_u32 s96, s5, 2
    s_cmp_ge_u32 s96, 5
    s_cselect_b32 s100, 5, 0
    s_sub_u32 s96, s96, s100
    s_lshl_b32 s96, s96, 13
    v_add_u32 v15, s96, v10
    v_add_u32 v16, s96, v11
    ds_read_b64_tr_b16 v[104:105], v15 offset:8192
    ds_read_b64_tr_b16 v[106:107], v15 offset:8704
    ds_read_b64_tr_b16 v[108:109], v16 offset:8192
    ds_read_b64_tr_b16 v[110:111], v16 offset:8704
    s_waitcnt vmcnt(8) lgkmcnt(8)
    v_mfma_f32_32x32x16_bf16 v[64:79], a[120:123], a[8:11], v[64:79]
    v_mfma_f32_32x32x16_bf16 v[80:95], a[124:127], a[8:11], v[80:95]
    s_add_u32 s80, s5, 4
    s_cmp_ge_u32 s80, 5
    s_cselect_b32 s100, 5, 0
    s_sub_u32 s80, s80, s100
    s_lshl_b32 s80, s80, 13
    s_add_u32 s80, s80, s6
    buffer_load_dwordx4 a[36:39], v9, s[48:51], s80 offen offset:2048 sc1
    ds_read_b64_tr_b16 a[120:121], v15 offset:10240
    ds_read_b64_tr_b16 a[122:123], v15 offset:10752
    ds_read_b64_tr_b16 a[124:125], v16 offset:10240
    ds_read_b64_tr_b16 a[126:127], v16 offset:10752
    s_waitcnt vmcnt(8) lgkmcnt(8)
    v_mfma_f32_32x32x16_bf16 v[64:79], v[96:99], a[12:15], v[64:79]
    v_mfma_f32_32x32x16_bf16 v[80:95], v[100:103], a[12:15], v[80:95]
    s_waitcnt vmcnt(4)
    s_add_u32 s88, s14, 32
    v_mov_b32 v25, s76
    s_mov_b64 exec, 1
    s_cmp_eq_u32 s77, 1
    s_cbranch_scc0 L_sl_52
    buffer_store_dword v25, off, s[48:51], s88
    s_branch L_sd_53
L_sl_52:
    buffer_store_dword v25, off, s[48:51], s88 sc1
L_sd_53:
    s_mov_b64 exec, -1
    s_add_u32 s80, s5, 0
    s_cmp_ge_u32 s80, 5
    s_cselect_b32 s100, 5, 0
    s_sub_u32 s80, s80, s100
    s_lshl_b32 s80, s80, 13
    s_add_u32 s80, s80, s7
    buffer_load_dwordx4 a[40:43], v19, s[48:51], s80 offen offset:0 sc1
    s_add_u32 s96, s5, 3
    s_cmp_ge_u32 s96, 5
    s_cselect_b32 s100, 5, 0
    s_sub_u32 s96, s96, s100
    s_lshl_b32 s96, s96, 13
    v_add_u32 v15, s96, v10
    v_add_u32 v16, s96, v11
    ds_read_b64_tr_b16 v[96:97], v15 offset:8192
    ds_read_b64_tr_b16 v[98:99], v15 offset:8704
    ds_read_b64_tr_b16 v[100:101], v16 offset:8192
    ds_read_b64_tr_b16 v[102:103], v16 offset:8704
    s_waitcnt lgkmcnt(8)
    v_mfma_f32_32x32x16_bf16 v[64:79], v[104:107], a[16:19], v[64:79]
    v_mfma_f32_32x32x16_bf16 v[80:95], v[108:111], a[16:19], v[80:95]
    s_add_u32 s80, s5, 1
    s_cmp_ge_u32 s80, 5
    s_cselect_b32 s100, 5, 0
    s_sub_u32 s80, s80, s100
    s_lshl_b32 s80, s80, 13
    s_add_u32 s80, s80, s7
    buffer_load_dwordx4 a[44:47], v19, s[48:51], s80 offen offset:0 sc1
    ds_read_b64_tr_b16 v[104:105], v15 offset:10240
    ds_read_b64_tr_b16 v[106:107], v15 offset:10752
    ds_read_b64_tr_b16 v[108:109], v16 offset:10240
    ds_read_b64_tr_b16 v[110:111], v16 offset:10752
    s_waitcnt lgkmcnt(8)
    v_mfma_f32_32x32x16_bf16 v[64:79], a[120:123], a[20:23], v[64:79]
    v_mfma_f32_32x32x16_bf16 v[80:95], a[124:127], a[20:23], v[80:95]
    s_mov_b32 s80, 5
    s_lshl_b32 s80, s80, 13
    s_add_u32 s80, s80, s6
    buffer_load_dwordx4 a[48:51], v9, s[48:51], s80 offen offset:0 sc1
    s_add_u32 s96, s5, 4
    s_cmp_ge_u32 s96, 5
    s_cselect_b32 s100, 5, 0
    s_sub_u32 s96, s96, s100
    s_lshl_b32 s96, s96, 13
    v_add_u32 v15, s96, v10
    v_add_u32 v16, s96, v11
    ds_read_b64_tr_b16 a[120:121], v15 offset:8192
    ds_read_b64_tr_b16 a[122:123], v15 offset:8704
    ds_read_b64_tr_b16 a[124:125], v16 offset:8192
    ds_read_b64_tr_b16 a[126:127], v16 offset:8704
    s_waitcnt vmcnt(7) lgkmcnt(8)
    v_mfma_f32_32x32x16_bf16 v[64:79], v[96:99], a[24:27], v[64:79]
    v_mfma_f32_32x32x16_bf16 v[80:95], v[100:103], a[24:27], v[80:95]
    buffer_load_dword v24, v21, s[48:51], 0 offen sc1
    s_mov_b32 s80, 5
    s_lshl_b32 s80, s80, 13
    s_add_u32 s80, s80, s6
    buffer_load_dwordx4 a[52:55], v9, s[48:51], s80 offen offset:2048 sc1
    ds_read_b64_tr_b16 v[96:97], v15 offset:10240
    ds_read_b64_tr_b16 v[98:99], v15 offset:10752
    ds_read_b64_tr_b16 v[100:101], v16 offset:10240
    ds_read_b64_tr_b16 v[102:103], v16 offset:10752
    s_waitcnt vmcnt(8) lgkmcnt(8)
    v_mfma_f32_32x32x16_bf16 v[64:79], v[104:107], a[28:31], v[64:79]
    v_mfma_f32_32x32x16_bf16 v[80:95], v[108:111], a[28:31], v[80:95]
    s_add_u32 s96, s5, 0
    s_cmp_ge_u32 s96, 5
    s_cselect_b32 s100, 5, 0
    s_sub_u32 s96, s96, s100
    s_lshl_b32 s96, s96, 13
    v_add_u32 v15, s96, v13
    v_add_u32 v16, s96, v14
    ds_read_b64_tr_b16 v[104:105], v15 offset:8192
    ds_read_b64_tr_b16 v[106:107], v15 offset:8704
    ds_read_b64_tr_b16 v[108:109], v16 offset:8192
    ds_read_b64_tr_b16 v[110:111], v16 offset:8704
    s_waitcnt vmcnt(7) lgkmcnt(8)
    v_mfma_f32_32x32x16_bf16 v[64:79], a[120:123], a[32:35], v[64:79]
    v_mfma_f32_32x32x16_bf16 v[80:95], a[124:127], a[32:35], v[80:95]
    s_add_u32 s96, s5, 1
    s_cmp_ge_u32 s96, 5
    s_cselect_b32 s100, 5, 0
    s_sub_u32 s96, s96, s100
    s_lshl_b32 s96, s96, 13
    v_add_u32 v15, s96, v13
    v_add_u32 v16, s96, v14
    ds_read_b64_tr_b16 a[120:121], v15 offset:8192
    ds_read_b64_tr_b16 a[122:123], v15 offset:8704
    ds_read_b64_tr_b16 a[124:125], v16 offset:8192
    ds_read_b64_tr_b16 a[126:127], v16 offset:8704
    s_waitcnt vmcnt(6) lgkmcnt(8)
    v_mfma_f32_32x32x16_bf16 v[64:79], v[96:99], a[36:39], v[64:79]
    v_mfma_f32_32x32x16_bf16 v[80:95], v[100:103], a[36:39], v[80:95]
    s_waitcnt vmcnt(1)
    s_mov_b32 s94, 40000
L_pf_54:
    v_cmp_ne_u32 vcc, s76, v24
    s_nop 1
    s_and_b32 s88, vcc_lo, 0x7001000
    s_cbranch_scc0 L_pfd_55
    s_sub_u32 s94, s94, 1
    s_cbranch_scc1 L_pfd_55
    buffer_load_dword v24, v21, s[48:51], 0 offen sc1
    s_waitcnt vmcnt(0)
    s_branch L_pf_54
L_pfd_55:
    s_mov_b32 s80, 6
    s_lshl_b32 s80, s80, 13
    s_add_u32 s80, s80, s6
    buffer_load_dwordx4 a[56:59], v9, s[48:51], s80 offen offset:0 sc1
    s_mov_b32 s80, 6
    s_lshl_b32 s80, s80, 13
    s_add_u32 s80, s80, s6
    buffer_load_dwordx4 a[60:63], v9, s[48:51], s80 offen offset:2048 sc1
    s_waitcnt lgkmcnt(4)
    v_mfma_f32_32x32x16_bf16 v[32:47], v[104:107], a[40:43], 0
    v_mfma_f32_32x32x16_bf16 v[48:63], v[108:111], a[40:43], 0
    s_mov_b32 s80, 7
    s_lshl_b32 s80, s80, 13
    s_add_u32 s80, s80, s6
    buffer_load_dwordx4 a[64:67], v9, s[48:51], s80 offen offset:0 sc1
    s_mov_b32 s80, 7
    s_lshl_b32 s80, s80, 13
    s_add_u32 s80, s80, s6
    buffer_load_dwordx4 a[68:71], v9, s[48:51], s80 offen offset:2048 sc1
    s_barrier
    s_mov_b32 s96, 5
    s_lshl_b32 s96, s96, 13
    v_add_u32 v15, s96, v10
    v_add_u32 v16, s96, v11
    ds_read_b64_tr_b16 v[96:97], v15 offset:8192
    ds_read_b64_tr_b16 v[98:99], v15 offset:8704
    ds_read_b64_tr_b16 v[100:101], v16 offset:8192
    ds_read_b64_tr_b16 v[102:103], v16 offset:8704
    ds_read_b64_tr_b16 v[104:105], v15 offset:10240
    ds_read_b64_tr_b16 v[106:107], v15 offset:10752
    ds_read_b64_tr_b16 v[108:109], v16 offset:10240
    ds_read_b64_tr_b16 v[110:111], v16 offset:10752
    s_waitcnt lgkmcnt(8)
    v_mfma_f32_32x32x16_bf16 v[32:47], a[120:123], a[44:47], v[32:47]
    v_mfma_f32_32x32x16_bf16 v[48:63], a[124:127], a[44:47], v[48:63]
    s_mov_b32 s80, 8
    s_lshl_b32 s80, s80, 13
    s_add_u32 s80, s80, s6
    buffer_load_dwordx4 a[72:75], v9, s[48:51], s80 offen offset:0 sc1
    s_mov_b32 s96, 6
    s_lshl_b32 s96, s96, 13
    v_add_u32 v15, s96, v10
    v_add_u32 v16, s96, v11
    ds_read_b64_tr_b16 a[120:121], v15 offset:8192
    ds_read_b64_tr_b16 a[122:123], v15 offset:8704
    ds_read_b64_tr_b16 a[124:125], v16 offset:8192
    ds_read_b64_tr_b16 a[126:127], v16 offset:8704
    s_waitcnt lgkmcnt(8)
    v_mfma_f32_32x32x16_bf16 v[64:79], v[96:99], a[48:51], v[64:79]
    v_mfma_f32_32x32x16_bf16 v[80:95], v[100:103], a[48:51], v[80:95]
    s_add_u32 s96, s15, 0
    s_and_b32 s96, s96, 3
    s_lshl_b32 s97, s15, 1
    s_and_b32 s97, s97, 4
    s_xor_b32 s97, s97, 4
    s_add_u32 s96, s96, s97
    s_lshl_b32 s97, s96, 13
    s_add_u32 s97, s97, s82
    s_lshl_b32 s96, s96, 16
    s_add_u32 m0, s97, 98304
    s_nop 0
    buffer_load_dwordx4 v12, s[44:47], s96 offen lds
    buffer_load_dword v24, v21, s[48:51], 0 offen sc1
    s_mov_b32 s80, 8
    s_lshl_b32 s80, s80, 13
    s_add_u32 s80, s80, s6
    buffer_load_dwordx4 a[76:79], v9, s[48:51], s80 offen offset:2048 sc1
    ds_read_b64_tr_b16 v[96:97], v15 offset:10240
    ds_read_b64_tr_b16 v[98:99], v15 offset:10752
    ds_read_b64_tr_b16 v[100:101], v16 offset:10240
    ds_read_b64_tr_b16 v[102:103], v16 offset:10752
    s_waitcnt vmcnt(8) lgkmcnt(8)
    v_mfma_f32_32x32x16_bf16 v[64:79], v[104:107], a[52:55], v[64:79]
    v_mfma_f32_32x32x16_bf16 v[80:95], v[108:111], a[52:55], v[80:95]
    s_add_u32 s96, s15, 1
    s_and_b32 s96, s96, 3
    s_lshl_b32 s97, s15, 1
    s_and_b32 s97, s97, 4
    s_xor_b32 s97, s97, 4
    s_add_u32 s96, s96, s97
    s_lshl_b32 s97, s96, 13
    s_add_u32 s97, s97, s82
    s_lshl_b32 s96, s96, 16
    s_add_u32 m0, s97, 98304
    s_nop 0
    buffer_load_dwordx4 v12, s[44:47], s96 offen lds
    s_mov_b32 s96, 7
    s_lshl_b32 s96, s96, 13
    v_add_u32 v15, s96, v10
    v_add_u32 v16, s96, v11
    ds_read_b64_tr_b16 v[104:105], v15 offset:8192
    ds_read_b64_tr_b16 v[106:107], v15 offset:8704
    ds_read_b64_tr_b16 v[108:109], v16 offset:8192
    ds_read_b64_tr_b16 v[110:111], v16 offset:8704
    s_waitcnt vmcnt(8) lgkmcnt(8)
    v_mfma_f32_32x32x16_bf16 v[64:79], a[120:123], a[56:59], v[64:79]
    v_mfma_f32_32x32x16_bf16 v[80:95], a[124:127], a[56:59], v[80:95]
    s_add_u32 s96, s15, 2
    s_and_b32 s96, s96, 3
    s_lshl_b32 s97, s15, 1
    s_and_b32 s97, s97, 4
    s_xor_b32 s97, s97, 4
    s_add_u32 s96, s96, s97
    s_lshl_b32 s97, s96, 13
    s_add_u32 s97, s97, s82
    s_lshl_b32 s96, s96, 16
    s_add_u32 m0, s97, 98304
    s_nop 0
    buffer_load_dwordx4 v12, s[44:47], s96 offen lds
    ds_read_b64_tr_b16 a[120:121], v15 offset:10240
    ds_read_b64_tr_b16 a[122:123], v15 offset:10752
    ds_read_b64_tr_b16 a[124:125], v16 offset:10240
    ds_read_b64_tr_b16 a[126:127], v16 offset:10752
    s_waitcnt vmcnt(8) lgkmcnt(8)
    v_mfma_f32_32x32x16_bf16 v[64:79], v[96:99], a[60:63], v[64:79]
    v_mfma_f32_32x32x16_bf16 v[80:95], v[100:103], a[60:63], v[80:95]
    s_add_u32 s96, s15, 3
    s_and_b32 s96, s96, 3
    s_lshl_b32 s97, s15, 1
    s_and_b32 s97, s97, 4
    s_xor_b32 s97, s97, 4
    s_add_u32 s96, s96, s97
    s_lshl_b32 s97, s96, 13
    s_add_u32 s97, s97, s82
    s_lshl_b32 s96, s96, 16
    s_add_u32 m0, s97, 98304
    s_nop 0
    buffer_load_dwordx4 v12, s[44:47], s96 offen lds
    s_waitcnt vmcnt(4)
    s_mov_b32 s94, 40000
L_pf_56:
    v_cmp_ne_u32 vcc, s76, v24
    s_nop 1
    s_and_b32 s88, vcc_lo, 0x30000000
    s_cbranch_scc0 L_pfd_57
    s_sub_u32 s94, s94, 1
    s_cbranch_scc1 L_pfd_57
    buffer_load_dword v24, v21, s[48:51], 0 offen sc1
    s_waitcnt vmcnt(0)
    s_branch L_pf_56
L_pfd_57:
    s_mov_b32 s80, 9
    s_lshl_b32 s80, s80, 13
    s_add_u32 s80, s80, s6
    buffer_load_dwordx4 a[80:83], v9, s[48:51], s80 offen offset:0 sc1
    s_mov_b32 s80, 9
    s_lshl_b32 s80, s80, 13
    s_add_u32 s80, s80, s6
    buffer_load_dwordx4 a[84:87], v9, s[48:51], s80 offen offset:2048 sc1
    s_mov_b32 s96, 8
    s_lshl_b32 s96, s96, 13
    v_add_u32 v15, s96, v10
    v_add_u32 v16, s96, v11
    ds_read_b64_tr_b16 v[96:97], v15 offset:8192
    ds_read_b64_tr_b16 v[98:99], v15 offset:8704
    ds_read_b64_tr_b16 v[100:101], v16 offset:8192
    ds_read_b64_tr_b16 v[102:103], v16 offset:8704
    s_waitcnt lgkmcnt(8)
    v_mfma_f32_32x32x16_bf16 v[64:79], v[104:107], a[64:67], v[64:79]
    v_mfma_f32_32x32x16_bf16 v[80:95], v[108:111], a[64:67], v[80:95]
    s_mov_b32 s80, 10
    s_lshl_b32 s80, s80, 13
    s_add_u32 s80, s80, s6
    s_lshr_b32 s100, s72, 1
    s_and_b32 s100, s100, s16
    s_cselect_b32 s80, 0x40000000, s80
    buffer_load_dwordx4 a[88:91], v9, s[48:51], s80 offen offset:0 sc1
    s_mov_b32 s80, 10
    s_lshl_b32 s80, s80, 13
    s_add_u32 s80, s80, s6
    s_lshr_b32 s100, s72, 1
    s_and_b32 s100, s100, s16
    s_cselect_b32 s80, 0x40000000, s80
    buffer_load_dwordx4 a[92:95], v9, s[48:51], s80 offen offset:2048 sc1
    ds_read_b64_tr_b16 v[104:105], v15 offset:10240
    ds_read_b64_tr_b16 v[106:107], v15 offset:10752
    ds_read_b64_tr_b16 v[108:109], v16 offset:10240
    ds_read_b64_tr_b16 v[110:111], v16 offset:10752
    s_waitcnt lgkmcnt(8)
    v_mfma_f32_32x32x16_bf16 v[64:79], a[120:123], a[68:71], v[64:79]
    v_mfma_f32_32x32x16_bf16 v[80:95], a[124:127], a[68:71], v[80:95]
    s_add_u32 s80, s5, 2
    s_cmp_ge_u32 s80, 5
    s_cselect_b32 s100, 5, 0
    s_sub_u32 s80, s80, s100
    s_lshl_b32 s80, s80, 13
    s_add_u32 s80, s80, s7
    buffer_load_dwordx4 a[96:99], v19, s[48:51], s80 offen offset:0 sc1
    s_mov_b32 s96, 9
    s_lshl_b32 s96, s96, 13
    v_add_u32 v15, s96, v10
    v_add_u32 v16, s96, v11
    ds_read_b64_tr_b16 a[120:121], v15 offset:8192
    ds_read_b64_tr_b16 a[122:123], v15 offset:8704
    ds_read_b64_tr_b16 a[124:125], v16 offset:8192
    ds_read_b64_tr_b16 a[126:127], v16 offset:8704
    s_waitcnt lgkmcnt(8)
    v_mfma_f32_32x32x16_bf16 v[64:79], v[96:99], a[72:75], v[64:79]
    v_mfma_f32_32x32x16_bf16 v[80:95], v[100:103], a[72:75], v[80:95]
    s_add_u32 s80, s5, 3
    s_cmp_ge_u32 s80, 5
    s_cselect_b32 s100, 5, 0
    s_sub_u32 s80, s80, s100
    s_lshl_b32 s80, s80, 13
    s_add_u32 s80, s80, s7
    buffer_load_dwordx4 a[100:103], v19, s[48:51], s80 offen offset:0 sc1
    ds_read_b64_tr_b16 v[96:97], v15 offset:10240
    ds_read_b64_tr_b16 v[98:99], v15 offset:10752
    ds_read_b64_tr_b16 v[100:101], v16 offset:10240
    ds_read_b64_tr_b16 v[102:103], v16 offset:10752
    s_waitcnt vmcnt(9) lgkmcnt(8)
    v_mfma_f32_32x32x16_bf16 v[64:79], v[104:107], a[76:79], v[64:79]
    v_mfma_f32_32x32x16_bf16 v[80:95], v[108:111], a[76:79], v[80:95]
    s_add_u32 s80, s5, 4
    s_cmp_ge_u32 s80, 5
    s_cselect_b32 s100, 5, 0
    s_sub_u32 s80, s80, s100
    s_lshl_b32 s80, s80, 13
    s_add_u32 s80, s80, s7
    buffer_load_dwordx4 a[104:107], v19, s[48:51], s80 offen offset:0 sc1
    s_mov_b32 s96, 10
    s_lshl_b32 s96, s96, 13
    v_add_u32 v15, s96, v10
    v_add_u32 v16, s96, v11
    ds_read_b64_tr_b16 v[104:105], v15 offset:8192
    ds_read_b64_tr_b16 v[106:107], v15 offset:8704
    ds_read_b64_tr_b16 v[108:109], v16 offset:8192
    ds_read_b64_tr_b16 v[110:111], v16 offset:8704
    s_waitcnt vmcnt(6) lgkmcnt(8)
    v_mfma_f32_32x32x16_bf16 v[64:79], a[120:123], a[80:83], v[64:79]
    v_mfma_f32_32x32x16_bf16 v[80:95], a[124:127], a[80:83], v[80:95]
    s_add_u32 s80, s5, 5
    s_cmp_ge_u32 s80, 10
    s_cselect_b32 s100, 5, 0
    s_sub_u32 s80, s80, s100
    s_lshl_b32 s80, s80, 13
    s_add_u32 s80, s80, s7
    buffer_load_dwordx4 a[108:111], v19, s[48:51], s80 offen offset:0 sc1
    ds_read_b64_tr_b16 a[120:121], v15 offset:10240
    ds_read_b64_tr_b16 a[122:123], v15 offset:10752
    ds_read_b64_tr_b16 a[124:125], v16 offset:10240
    ds_read_b64_tr_b16 a[126:127], v16 offset:10752
    s_waitcnt vmcnt(6) lgkmcnt(8)
    v_mfma_f32_32x32x16_bf16 v[64:79], v[96:99], a[84:87], v[64:79]
    v_mfma_f32_32x32x16_bf16 v[80:95], v[100:103], a[84:87], v[80:95]
    s_add_u32 s80, s5, 6
    s_cmp_ge_u32 s80, 10
    s_cselect_b32 s100, 5, 0
    s_sub_u32 s80, s80, s100
    s_lshl_b32 s80, s80, 13
    s_add_u32 s80, s80, s7
    buffer_load_dwordx4 a[112:115], v19, s[48:51], s80 offen offset:0 sc1
    s_add_u32 s96, s5, 2
    s_cmp_ge_u32 s96, 5
    s_cselect_b32 s100, 5, 0
    s_sub_u32 s96, s96, s100
    s_lshl_b32 s96, s96, 13
    v_add_u32 v15, s96, v13
    v_add_u32 v16, s96, v14
    ds_read_b64_tr_b16 v[96:97], v15 offset:8192
    ds_read_b64_tr_b16 v[98:99], v15 offset:8704
    ds_read_b64_tr_b16 v[100:101], v16 offset:8192
    ds_read_b64_tr_b16 v[102:103], v16 offset:8704
    s_waitcnt vmcnt(6) lgkmcnt(8)
    v_mfma_f32_32x32x16_bf16 v[64:79], v[104:107], a[88:91], v[64:79]
    v_mfma_f32_32x32x16_bf16 v[80:95], v[108:111], a[88:91], v[80:95]
    s_add_u32 s80, s5, 7
    s_cmp_ge_u32 s80, 10
    s_cselect_b32 s100, 5, 0
    s_sub_u32 s80, s80, s100
    s_lshl_b32 s80, s80, 13
    s_add_u32 s80, s80, s7
    buffer_load_dwordx4 a[116:119], v19, s[48:51], s80 offen offset:0 sc1
    s_add_u32 s96, s5, 3
    s_cmp_ge_u32 s96, 5
    s_cselect_b32 s100, 5, 0
    s_sub_u32 s96, s96, s100
    s_lshl_b32 s96, s96, 13
    v_add_u32 v15, s96, v13
    v_add_u32 v16, s96, v14
    ds_read_b64_tr_b16 v[104:105], v15 offset:8192
    ds_read_b64_tr_b16 v[106:107], v15 offset:8704
    ds_read_b64_tr_b16 v[108:109], v16 offset:8192
    ds_read_b64_tr_b16 v[110:111], v16 offset:8704
    s_waitcnt vmcnt(6) lgkmcnt(8)
    v_mfma_f32_32x32x16_bf16 v[64:79], a[120:123], a[92:95], v[64:79]
    v_mfma_f32_32x32x16_bf16 v[80:95], a[124:127], a[92:95], v[80:95]
    s_add_u32 s80, s5, 8
    s_cmp_ge_u32 s80, 10
    s_cselect_b32 s100, 5, 0
    s_sub_u32 s80, s80, s100
    s_lshl_b32 s80, s80, 13
    s_add_u32 s80, s80, s7
    buffer_load_dwordx4 a[0:3], v19, s[48:51], s80 offen offset:0 sc1
    s_add_u32 s80, s5, 9
    s_cmp_ge_u32 s80, 10
    s_cselect_b32 s100, 5, 0
    s_sub_u32 s80, s80, s100
    s_lshl_b32 s80, s80, 13
    s_add_u32 s80, s80, s7
    buffer_load_dwordx4 a[4:7], v19, s[48:51], s80 offen offset:0 sc1
    s_mov_b32 s80, 10
    s_lshl_b32 s80, s80, 13
    s_add_u32 s80, s80, s7
    s_and_b32 s100, s16, s74
    s_cselect_b32 s80, 0x40000000, s80
    buffer_load_dwordx4 a[8:11], v19, s[48:51], s80 offen offset:0 sc1
    s_waitcnt lgkmcnt(0)
    s_lshl_b32 s88, s72, 12
    s_and_b32 s89, s15, 2
    s_lshl_b32 s89, s89, 14
    s_add_u32 s88, s88, s89
    s_add_u32 s89, s88, 98304
    s_xor_b32 s88, s88, 0x2000
    s_add_u32 s88, s88, 98304
    v_add_u32 v25, s89, v22
    v_add_u32 v26, s88, v22
    ds_write_b128 v25, v[80:83] offset:0
    ds_write_b128 v25, v[84:87] offset:1024
    ds_write_b128 v25, v[88:91] offset:2048
    ds_write_b128 v25, v[92:95] offset:3072
    s_xor_b32 s89, s15, s74
    s_and_b32 s89, s89, 1
    s_lshl_b32 s89, s89, 17
    s_xor_b32 s90, s86, s89
    s_bfe_u32 s89, s72, 0x10001
    s_lshl_b32 s89, s89, 11
    s_add_u32 s90, s90, s89
    s_waitcnt lgkmcnt(0)
    s_barrier
    ds_read_b128 v[80:83], v26 offset:0
    ds_read_b128 v[84:87], v26 offset:1024
    ds_read_b128 v[88:91], v26 offset:2048
    ds_read_b128 v[92:95], v26 offset:3072
    s_waitcnt lgkmcnt(2)
    v_add_f32 v64, v64, v80
    v_add_f32 v65, v65, v81
    v_add_f32 v66, v66, v82
    v_add_f32 v67, v67, v83
    v_add_f32 v68, v68, v84
    v_add_f32 v69, v69, v85
    v_add_f32 v70, v70, v86
    v_add_f32 v71, v71, v87
    v_cvt_pk_bf16_f32 v64, v64, v65
    v_cvt_pk_bf16_f32 v65, v66, v67
    v_cvt_pk_bf16_f32 v66, v68, v69
    v_cvt_pk_bf16_f32 v67, v70, v71
    buffer_store_dwordx4 v[64:67], v22, s[48:51], s90 offen offset:0 sc1
    s_waitcnt lgkmcnt(0)
    v_add_f32 v72, v72, v88
    v_add_f32 v73, v73, v89
    v_add_f32 v74, v74, v90
    v_add_f32 v75, v75, v91
    v_add_f32 v76, v76, v92
    v_add_f32 v77, v77, v93
    v_add_f32 v78, v78, v94
    v_add_f32 v79, v79, v95
    v_cvt_pk_bf16_f32 v72, v72, v73
    v_cvt_pk_bf16_f32 v73, v74, v75
    v_cvt_pk_bf16_f32 v74, v76, v77
    v_cvt_pk_bf16_f32 v75, v78, v79
    buffer_store_dwordx4 v[72:75], v22, s[48:51], s90 offen offset:1024 sc1
    s_barrier
    s_add_u32 s96, s5, 4
    s_cmp_ge_u32 s96, 5
    s_cselect_b32 s100, 5, 0
    s_sub_u32 s96, s96, s100
    s_lshl_b32 s96, s96, 13
    v_add_u32 v15, s96, v13
    v_add_u32 v16, s96, v14
    ds_read_b64_tr_b16 a[120:121], v15 offset:8192
    ds_read_b64_tr_b16 a[122:123], v15 offset:8704
    ds_read_b64_tr_b16 a[124:125], v16 offset:8192
    ds_read_b64_tr_b16 a[126:127], v16 offset:8704
    s_waitcnt vmcnt(10)
    v_mfma_f32_32x32x16_bf16 v[32:47], v[96:99], a[96:99], v[32:47]
    v_mfma_f32_32x32x16_bf16 v[48:63], v[100:103], a[96:99], v[48:63]
    s_add_u32 s96, s15, 0
    s_and_b32 s96, s96, 3
    s_lshl_b32 s97, s15, 1
    s_and_b32 s97, s97, 4
    s_xor_b32 s97, s97, 0
    s_add_u32 s96, s96, s97
    s_lshl_b32 s97, s96, 13
    s_add_u32 s97, s97, s82
    s_lshl_b32 s96, s96, 16
    s_add_u32 m0, s97, 98304
    s_nop 0
    buffer_load_dwordx4 v12, s[44:47], s96 offen lds
    s_add_u32 s96, s5, 5
    s_cmp_ge_u32 s96, 10
    s_cselect_b32 s100, 5, 0
    s_sub_u32 s96, s96, s100
    s_lshl_b32 s96, s96, 13
    v_add_u32 v15, s96, v13
    v_add_u32 v16, s96, v14
    ds_read_b64_tr_b16 v[96:97], v15 offset:8192
    ds_read_b64_tr_b16 v[98:99], v15 offset:8704
    ds_read_b64_tr_b16 v[100:101], v16 offset:8192
    ds_read_b64_tr_b16 v[102:103], v16 offset:8704
    s_waitcnt vmcnt(10)
    v_mfma_f32_32x32x16_bf16 v[32:47], v[104:107], a[100:103], v[32:47]
    v_mfma_f32_32x32x16_bf16 v[48:63], v[108:111], a[100:103], v[48:63]
    s_add_u32 s96, s15, 1
    s_and_b32 s96, s96, 3
    s_lshl_b32 s97, s15, 1
    s_and_b32 s97, s97, 4
    s_xor_b32 s97, s97, 0
    s_add_u32 s96, s96, s97
    s_lshl_b32 s97, s96, 13
    s_add_u32 s97, s97, s82
    s_lshl_b32 s96, s96, 16
    s_add_u32 m0, s97, 98304
    s_nop 0
    buffer_load_dwordx4 v12, s[44:47], s96 offen lds
    s_cmp_eq_u32 s2, 192
    s_cbranch_scc0 L_nb_58
    s_cmp_eq_u32 s72, 0
    s_cbranch_scc0 L_nb_58
    s_mov_b32 s88, 18120704
    s_mov_b32 s94, 40000
L_bp_59:
    buffer_load_dwordx4 v[8:11], v22, s[48:51], s88 offen sc1
    s_waitcnt vmcnt(0)
    v_cmp_ne_u32 vcc, s76, v8
    v_cmp_ne_u32 s[98:99], s76, v9
    s_nop 1
    s_or_b64 vcc, vcc, s[98:99]
    v_cmp_ne_u32 s[98:99], s76, v10
    s_nop 1
    s_or_b64 vcc, vcc, s[98:99]
    v_cmp_ne_u32 s[98:99], s76, v11
    s_nop 1
    s_or_b64 vcc, vcc, s[98:99]
    s_cbranch_vccz L_bpd_60
    s_sub_u32 s94, s94, 1
    s_cbranch_scc0 L_bp_59
L_bpd_60:
    v_mov_b32 v25, s87
    s_mov_b32 s88, 18153472
    s_mov_b64 exec, 1
    buffer_store_dword v25, off, s[48:51], s88
    s_mov_b64 exec, -1
    s_waitcnt vmcnt(0)
L_nb_58:
    s_add_u32 s96, s5, 6
    s_cmp_ge_u32 s96, 10
    s_cselect_b32 s100, 5, 0
    s_sub_u32 s96, s96, s100
    s_lshl_b32 s96, s96, 13
    v_add_u32 v15, s96, v13
    v_add_u32 v16, s96, v14
    ds_read_b64_tr_b16 v[104:105], v15 offset:8192
    ds_read_b64_tr_b16 v[106:107], v15 offset:8704
    ds_read_b64_tr_b16 v[108:109], v16 offset:8192
    ds_read_b64_tr_b16 v[110:111], v16 offset:8704
    s_waitcnt vmcnt(10) lgkmcnt(8)
    v_mfma_f32_32x32x16_bf16 v[32:47], a[120:123], a[104:107], v[32:47]
    v_mfma_f32_32x32x16_bf16 v[48:63], a[124:127], a[104:107], v[48:63]
    s_add_u32 s96, s15, 2
    s_and_b32 s96, s96, 3
    s_lshl_b32 s97, s15, 1
    s_and_b32 s97, s97, 4
    s_xor_b32 s97, s97, 0
    s_add_u32 s96, s96, s97
    s_lshl_b32 s97, s96, 13
    s_add_u32 s97, s97, s82
    s_lshl_b32 s96, s96, 16
    s_add_u32 m0, s97, 98304
    s_nop 0
    buffer_load_dwordx4 v12, s[44:47], s96 offen lds
    s_add_u32 s96, s5, 7
    s_cmp_ge_u32 s96, 10
    s_cselect_b32 s100, 5, 0
    s_sub_u32 s96, s96, s100
    s_lshl_b32 s96, s96, 13
    v_add_u32 v15, s96, v13
    v_add_u32 v16, s96, v14
    ds_read_b64_tr_b16 a[120:121], v15 offset:8192
    ds_read_b64_tr_b16 a[122:123], v15 offset:8704
    ds_read_b64_tr_b16 a[124:125], v16 offset:8192
    ds_read_b64_tr_b16 a[126:127], v16 offset:8704
    s_waitcnt vmcnt(10) lgkmcnt(8)
    v_mfma_f32_32x32x16_bf16 v[32:47], v[96:99], a[108:111], v[32:47]
    v_mfma_f32_32x32x16_bf16 v[48:63], v[100:103], a[108:111], v[48:63]
    s_add_u32 s96, s15, 3
    s_and_b32 s96, s96, 3
    s_lshl_b32 s97, s15, 1
    s_and_b32 s97, s97, 4
    s_xor_b32 s97, s97, 0
    s_add_u32 s96, s96, s97
    s_lshl_b32 s97, s96, 13
    s_add_u32 s97, s97, s82
    s_lshl_b32 s96, s96, 16
    s_add_u32 m0, s97, 98304
    s_nop 0
    buffer_load_dwordx4 v12, s[44:47], s96 offen lds
    s_add_u32 s96, s5, 8
    s_cmp_ge_u32 s96, 10
    s_cselect_b32 s100, 5, 0
    s_sub_u32 s96, s96, s100
    s_lshl_b32 s96, s96, 13
    v_add_u32 v15, s96, v13
    v_add_u32 v16, s96, v14
    ds_read_b64_tr_b16 v[96:97], v15 offset:8192
    ds_read_b64_tr_b16 v[98:99], v15 offset:8704
    ds_read_b64_tr_b16 v[100:101], v16 offset:8192
    ds_read_b64_tr_b16 v[102:103], v16 offset:8704
    s_waitcnt vmcnt(10) lgkmcnt(8)
    v_mfma_f32_32x32x16_bf16 v[32:47], v[104:107], a[112:115], v[32:47]
    v_mfma_f32_32x32x16_bf16 v[48:63], v[108:111], a[112:115], v[48:63]
    s_add_u32 s96, s5, 9
    s_cmp_ge_u32 s96, 10
    s_cselect_b32 s100, 5, 0
    s_sub_u32 s96, s96, s100
    s_lshl_b32 s96, s96, 13
    v_add_u32 v15, s96, v13
    v_add_u32 v16, s96, v14
    ds_read_b64_tr_b16 v[104:105], v15 offset:8192
    ds_read_b64_tr_b16 v[106:107], v15 offset:8704
    ds_read_b64_tr_b16 v[108:109], v16 offset:8192
    ds_read_b64_tr_b16 v[110:111], v16 offset:8704
    s_waitcnt vmcnt(9) lgkmcnt(8)
    v_mfma_f32_32x32x16_bf16 v[32:47], a[120:123], a[116:119], v[32:47]
    v_mfma_f32_32x32x16_bf16 v[48:63], a[124:127], a[116:119], v[48:63]
    s_mov_b32 s96, 10
    s_lshl_b32 s96, s96, 13
    v_add_u32 v15, s96, v13
    v_add_u32 v16, s96, v14
    ds_read_b64_tr_b16 a[120:121], v15 offset:8192
    ds_read_b64_tr_b16 a[122:123], v15 offset:8704
    ds_read_b64_tr_b16 a[124:125], v16 offset:8192
    ds_read_b64_tr_b16 a[126:127], v16 offset:8704
    s_waitcnt vmcnt(8) lgkmcnt(8)
    v_mfma_f32_32x32x16_bf16 v[32:47], v[96:99], a[0:3], v[32:47]
    v_mfma_f32_32x32x16_bf16 v[48:63], v[100:103], a[0:3], v[48:63]
    v_and_b32 v26, 31, v0
    v_lshlrev_b32 v26, 3, v26
    v_and_b32 v28, 0x38, v0
    s_lshr_b32 s89, s72, 1
    s_lshl_b32 s89, s89, 6
    s_add_u32 s89, s89, s85
    buffer_load_dwordx2 v[26:27], v26, s[48:51], s85 offen sc1
    buffer_load_dwordx2 v[28:29], v28, s[48:51], s89 offen sc1
    buffer_load_dword v24, v21, s[48:51], 0 offen sc1
    s_waitcnt vmcnt(10) lgkmcnt(4)
    v_mfma_f32_32x32x16_bf16 v[32:47], v[104:107], a[4:7], v[32:47]
    v_mfma_f32_32x32x16_bf16 v[48:63], v[108:111], a[4:7], v[48:63]
    s_waitcnt vmcnt(9) lgkmcnt(0)
    v_mfma_f32_32x32x16_bf16 v[32:47], a[120:123], a[8:11], v[32:47]
    v_mfma_f32_32x32x16_bf16 v[48:63], a[124:127], a[8:11], v[48:63]
    s_and_b32 s88, s15, 2
    s_add_u32 s88, s88, s74
    s_lshl_b32 s89, s68, 2
    s_add_u32 s88, s88, s89
    s_lshl_b32 s88, s88, 3
    s_add_u32 s88, s88, s3
    s_lshl_b32 s88, s88, 1
    s_and_b32 s89, s72, 1
    s_add_u32 s88, s88, s89
    s_lshl_b32 s88, s88, 6
    s_and_b32 s89, s72, 2
    s_lshl_b32 s89, s89, 1
    s_add_u32 s88, s88, s89
    s_add_u32 s88, s88, 18219008
    v_mov_b32 v25, s76
    s_waitcnt vmcnt(7)
    s_mov_b64 exec, 1
    buffer_store_dword v25, off, s[48:51], s88 sc1
    s_mov_b64 exec, -1
    s_mov_b32 s56, s20
    s_mov_b32 s57, s21
    s_mov_b32 s58, 2097152
    s_mov_b32 s59, 0x20000
    s_waitcnt vmcnt(4)
    s_barrier
    ds_read_b64_tr_b16 v[96:97], v17 offset:0
    ds_read_b64_tr_b16 v[98:99], v17 offset:512
    ds_read_b64_tr_b16 v[100:101], v18 offset:0
    ds_read_b64_tr_b16 v[102:103], v18 offset:512
    s_waitcnt vmcnt(2)
    s_mov_b32 s94, 40000
L_sp_61:
    v_cmp_ne_u32 vcc, s76, v27
    v_cmp_ne_u32 s[98:99], s76, v29
    s_nop 1
    s_or_b64 vcc, vcc, s[98:99]
    s_cbranch_vccz L_spd_62
    s_sub_u32 s94, s94, 1
    s_cbranch_scc1 L_spd_62
    v_and_b32 v26, 31, v0
    v_lshlrev_b32 v26, 3, v26
    v_and_b32 v28, 0x38, v0
    s_lshr_b32 s89, s72, 1
    s_lshl_b32 s89, s89, 6
    s_add_u32 s89, s89, s85
    buffer_load_dwordx2 v[26:27], v26, s[48:51], s85 offen sc1
    buffer_load_dwordx2 v[28:29], v28, s[48:51], s89 offen sc1
    s_waitcnt vmcnt(0)
    s_branch L_sp_61
L_spd_62:
    s_waitcnt vmcnt(1)
    s_mov_b32 s94, 40000
L_pf_63:
    v_cmp_ne_u32 vcc, s76, v24
    s_nop 1
    s_and_b32 s88, vcc_hi, 0xff
    s_cbranch_scc0 L_pfd_64
    s_sub_u32 s94, s94, 1
    s_cbranch_scc1 L_pfd_64
    buffer_load_dword v24, v21, s[48:51], 0 offen sc1
    s_waitcnt vmcnt(0)
    s_branch L_pf_63
L_pfd_64:
    s_lshl_b32 s93, s16, 21
    s_add_u32 s93, s93, 180224
    s_add_u32 s88, s93, 0
    buffer_load_dwordx4 a[0:3], v19, s[48:51], s88 offen sc1
    v_sub_f32 v27, 1.0, v26
    v_sub_f32 v28, 1.0, v28
    v_mul_f32 v32, v27, v32
    v_mul_f32 v33, v27, v33
    v_mul_f32 v34, v27, v34
    v_mul_f32 v35, v27, v35
    v_mul_f32 v36, v27, v36
    s_add_u32 s88, s93, 8192
    buffer_load_dwordx4 a[4:7], v19, s[48:51], s88 offen sc1
    v_mul_f32 v37, v27, v37
    v_mul_f32 v38, v27, v38
    v_mul_f32 v39, v27, v39
    v_mul_f32 v40, v27, v40
    v_mul_f32 v41, v27, v41
    s_add_u32 s88, s93, 16384
    buffer_load_dwordx4 a[8:11], v19, s[48:51], s88 offen sc1
    v_mul_f32 v42, v27, v42
    v_mul_f32 v43, v27, v43
    v_mul_f32 v44, v27, v44
    v_mul_f32 v45, v27, v45
    v_mul_f32 v46, v27, v46
    v_mul_f32 v47, v27, v47
    s_add_u32 s88, s93, 24576
    buffer_load_dwordx4 a[12:15], v19, s[48:51], s88 offen sc1
    v_mul_f32 v48, v27, v48
    v_mul_f32 v49, v27, v49
    v_mul_f32 v50, v27, v50
    v_mul_f32 v51, v27, v51
    v_mul_f32 v52, v27, v52
    s_add_u32 s88, s93, 32768
    buffer_load_dwordx4 a[16:19], v19, s[48:51], s88 offen sc1
    v_mul_f32 v53, v27, v53
    v_mul_f32 v54, v27, v54
    v_mul_f32 v55, v27, v55
    v_mul_f32 v56, v27, v56
    v_mul_f32 v57, v27, v57
    s_add_u32 s88, s93, 40960
    buffer_load_dwordx4 a[20:23], v19, s[48:51], s88 offen sc1
    v_mul_f32 v58, v27, v58
    v_mul_f32 v59, v27, v59
    v_mul_f32 v60, v27, v60
    v_mul_f32 v61, v27, v61
    v_mul_f32 v62, v27, v62
    v_mul_f32 v63, v27, v63
    ds_read_b64_tr_b16 v[104:105], v17 offset:8192
    ds_read_b64_tr_b16 v[106:107], v17 offset:8704
    ds_read_b64_tr_b16 v[108:109], v18 offset:8192
    ds_read_b64_tr_b16 v[110:111], v18 offset:8704
    s_add_u32 s88, s93, 49152
    buffer_load_dwordx4 a[24:27], v19, s[48:51], s88 offen sc1
    buffer_load_dword v24, v21, s[48:51], 0 offen sc1
    s_waitcnt vmcnt(7) lgkmcnt(4)
    v_mfma_f32_32x32x16_bf16 v[64:79], v[96:99], a[0:3], 0
    v_mfma_f32_32x32x16_bf16 v[80:95], v[100:103], a[0:3], 0
    ds_read_b64_tr_b16 v[96:97], v17 offset:16384
    ds_read_b64_tr_b16 v[98:99], v17 offset:16896
    ds_read_b64_tr_b16 v[100:101], v18 offset:16384
    ds_read_b64_tr_b16 v[102:103], v18 offset:16896
    s_add_u32 s88, s93, 57344
    buffer_load_dwordx4 a[28:31], v19, s[48:51], s88 offen sc1
    s_waitcnt vmcnt(7) lgkmcnt(4)
    v_mfma_f32_32x32x16_bf16 v[64:79], v[104:107], a[4:7], v[64:79]
    v_mfma_f32_32x32x16_bf16 v[80:95], v[108:111], a[4:7], v[80:95]
    ds_read_b64_tr_b16 v[104:105], v17 offset:24576
    ds_read_b64_tr_b16 v[106:107], v17 offset:25088
    ds_read_b64_tr_b16 v[108:109], v18 offset:24576
    ds_read_b64_tr_b16 v[110:111], v18 offset:25088
    s_waitcnt vmcnt(6) lgkmcnt(4)
    v_mfma_f32_32x32x16_bf16 v[64:79], v[96:99], a[8:11], v[64:79]
    v_mfma_f32_32x32x16_bf16 v[80:95], v[100:103], a[8:11], v[80:95]
    ds_read_b64_tr_b16 v[96:97], v17 offset:32768
    ds_read_b64_tr_b16 v[98:99], v17 offset:33280
    ds_read_b64_tr_b16 v[100:101], v18 offset:32768
    ds_read_b64_tr_b16 v[102:103], v18 offset:33280
    s_waitcnt vmcnt(5) lgkmcnt(4)
    v_mfma_f32_32x32x16_bf16 v[64:79], v[104:107], a[12:15], v[64:79]
    v_mfma_f32_32x32x16_bf16 v[80:95], v[108:111], a[12:15], v[80:95]
    ds_read_b64_tr_b16 v[104:105], v17 offset:40960
    ds_read_b64_tr_b16 v[106:107], v17 offset:41472
    ds_read_b64_tr_b16 v[108:109], v18 offset:40960
    ds_read_b64_tr_b16 v[110:111], v18 offset:41472
    s_waitcnt vmcnt(1)
    s_mov_b32 s94, 40000
L_pf_65:
    v_cmp_ne_u32 vcc, s76, v24
    s_nop 1
    s_and_b32 s88, vcc_hi, 0x30000
    s_cbranch_scc0 L_pfd_66
    s_sub_u32 s94, s94, 1
    s_cbranch_scc1 L_pfd_66
    buffer_load_dword v24, v21, s[48:51], 0 offen sc1
    s_waitcnt vmcnt(0)
    s_branch L_pf_65
L_pfd_66:
    s_xor_b32 s90, s86, 524288
    s_lshr_b32 s91, s72, 1
    s_lshl_b32 s91, s91, 7
    s_add_u32 s90, s90, s91
    v_bfe_u32 v8, v0, 1, 2
    v_and_b32 v9, 1, v0
    v_lshlrev_b32 v8, 10, v8
    v_lshl_add_u32 v8, v9, 9, v8
    v_lshrrev_b32 v9, 3, v0
    v_lshl_add_u32 v8, v9, 4, v8
    buffer_load_dwordx4 v[120:123], v8, s[48:51], s90 offen sc1
    s_waitcnt lgkmcnt(4)
    v_mfma_f32_32x32x16_bf16 v[64:79], v[96:99], a[16:19], v[64:79]
    v_mfma_f32_32x32x16_bf16 v[80:95], v[100:103], a[16:19], v[80:95]
    ds_read_b64_tr_b16 v[96:97], v17 offset:49152
    ds_read_b64_tr_b16 v[98:99], v17 offset:49664
    ds_read_b64_tr_b16 v[100:101], v18 offset:49152
    ds_read_b64_tr_b16 v[102:103], v18 offset:49664
    s_waitcnt lgkmcnt(4)
    v_mfma_f32_32x32x16_bf16 v[64:79], v[104:107], a[20:23], v[64:79]
    v_mfma_f32_32x32x16_bf16 v[80:95], v[108:111], a[20:23], v[80:95]
    ds_read_b64_tr_b16 v[104:105], v17 offset:57344
    ds_read_b64_tr_b16 v[106:107], v17 offset:57856
    ds_read_b64_tr_b16 v[108:109], v18 offset:57344
    ds_read_b64_tr_b16 v[110:111], v18 offset:57856
    s_waitcnt lgkmcnt(4)
    v_mfma_f32_32x32x16_bf16 v[64:79], v[96:99], a[24:27], v[64:79]
    v_mfma_f32_32x32x16_bf16 v[80:95], v[100:103], a[24:27], v[80:95]
    s_waitcnt vmcnt(1) lgkmcnt(0)
    v_mfma_f32_32x32x16_bf16 v[64:79], v[104:107], a[28:31], v[64:79]
    v_mfma_f32_32x32x16_bf16 v[80:95], v[108:111], a[28:31], v[80:95]
    s_nop 10
    v_pk_fma_f32 v[32:33], v[64:65], v[26:27], v[32:33] op_sel_hi:[1,0,1]
    v_pk_fma_f32 v[34:35], v[66:67], v[26:27], v[34:35] op_sel_hi:[1,0,1]
    ds_write_b128 v1, v[32:35] offset:0
    v_pk_fma_f32 v[36:37], v[68:69], v[26:27], v[36:37] op_sel_hi:[1,0,1]
    v_pk_fma_f32 v[38:39], v[70:71], v[26:27], v[38:39] op_sel_hi:[1,0,1]
    ds_write_b128 v2, v[36:39] offset:0
    v_pk_fma_f32 v[40:41], v[72:73], v[26:27], v[40:41] op_sel_hi:[1,0,1]
    v_pk_fma_f32 v[42:43], v[74:75], v[26:27], v[42:43] op_sel_hi:[1,0,1]
    ds_write_b128 v3, v[40:43] offset:0
    v_pk_fma_f32 v[44:45], v[76:77], v[26:27], v[44:45] op_sel_hi:[1,0,1]
    v_pk_fma_f32 v[46:47], v[78:79], v[26:27], v[46:47] op_sel_hi:[1,0,1]
    ds_write_b128 v4, v[44:47] offset:0
    v_pk_fma_f32 v[48:49], v[80:81], v[26:27], v[48:49] op_sel_hi:[1,0,1]
    v_pk_fma_f32 v[50:51], v[82:83], v[26:27], v[50:51] op_sel_hi:[1,0,1]
    ds_write_b128 v1, v[48:51] offset:128
    v_pk_fma_f32 v[52:53], v[84:85], v[26:27], v[52:53] op_sel_hi:[1,0,1]
    v_pk_fma_f32 v[54:55], v[86:87], v[26:27], v[54:55] op_sel_hi:[1,0,1]
    ds_write_b128 v2, v[52:55] offset:128
    v_pk_fma_f32 v[56:57], v[88:89], v[26:27], v[56:57] op_sel_hi:[1,0,1]
    v_pk_fma_f32 v[58:59], v[90:91], v[26:27], v[58:59] op_sel_hi:[1,0,1]
    ds_write_b128 v3, v[56:59] offset:128
    v_pk_fma_f32 v[60:61], v[92:93], v[26:27], v[60:61] op_sel_hi:[1,0,1]
    v_pk_fma_f32 v[62:63], v[94:95], v[26:27], v[62:63] op_sel_hi:[1,0,1]
    ds_write_b128 v4, v[60:63] offset:128
    s_waitcnt vmcnt(0)
    v_lshlrev_b32 v112, 16, v120
    v_and_b32 v113, 0xffff0000, v120
    v_lshlrev_b32 v114, 16, v121
    v_and_b32 v115, 0xffff0000, v121
    v_lshlrev_b32 v116, 16, v122
    v_and_b32 v117, 0xffff0000, v122
    v_lshlrev_b32 v118, 16, v123
    v_and_b32 v119, 0xffff0000, v123
    s_waitcnt lgkmcnt(0)
    s_barrier
    ds_read_b128 v[64:67], v5 offset:0
    ds_read_b128 v[68:71], v6 offset:0
    ds_read_b128 v[72:75], v5 offset:8192
    ds_read_b128 v[76:79], v6 offset:8192
    ds_read_b128 v[80:83], v5 offset:16384
    ds_read_b128 v[84:87], v6 offset:16384
    ds_read_b128 v[88:91], v5 offset:24576
    ds_read_b128 v[92:95], v6 offset:24576
    s_waitcnt lgkmcnt(4)
    v_pk_add_f32 v[64:65], v[64:65], v[72:73]
    v_pk_add_f32 v[66:67], v[66:67], v[74:75]
    v_pk_add_f32 v[68:69], v[68:69], v[76:77]
    v_pk_add_f32 v[70:71], v[70:71], v[78:79]
    s_waitcnt lgkmcnt(0)
    v_pk_add_f32 v[80:81], v[80:81], v[88:89]
    v_pk_add_f32 v[82:83], v[82:83], v[90:91]
    v_pk_add_f32 v[84:85], v[84:85], v[92:93]
    v_pk_add_f32 v[86:87], v[86:87], v[94:95]
    v_pk_add_f32 v[64:65], v[64:65], v[80:81]
    v_pk_add_f32 v[66:67], v[66:67], v[82:83]
    v_pk_add_f32 v[68:69], v[68:69], v[84:85]
    v_pk_add_f32 v[70:71], v[70:71], v[86:87]
    v_pk_fma_f32 v[64:65], v[112:113], v[28:29], v[64:65] op_sel_hi:[1,0,1]
    v_pk_fma_f32 v[66:67], v[114:115], v[28:29], v[66:67] op_sel_hi:[1,0,1]
    v_pk_fma_f32 v[68:69], v[116:117], v[28:29], v[68:69] op_sel_hi:[1,0,1]
    v_pk_fma_f32 v[70:71], v[118:119], v[28:29], v[70:71] op_sel_hi:[1,0,1]
    v_cvt_pk_bf16_f32 v72, v64, v65
    v_cvt_pk_bf16_f32 v73, v66, v67
    v_cvt_pk_bf16_f32 v74, v68, v69
    v_cvt_pk_bf16_f32 v75, v70, v71
    buffer_store_dwordx4 v[72:75], v7, s[56:59], 0 offen nt
    s_endpgm
L_kq:
    s_barrier
    ds_read_b64_tr_b16 v[80:81], v11 offset:0
    ds_read_b64_tr_b16 v[82:83], v11 offset:512
    ds_read_b64_tr_b16 v[84:85], v11 offset:2048
    ds_read_b64_tr_b16 v[86:87], v11 offset:2560
    ds_read_b64_tr_b16 v[88:89], v11 offset:4096
    ds_read_b64_tr_b16 v[90:91], v11 offset:4608
    s_waitcnt lgkmcnt(4)
    v_mfma_f32_32x32x16_bf16 v[64:79], v[80:83], a[0:3], 0
    ds_read_b64_tr_b16 v[92:93], v11 offset:6144
    ds_read_b64_tr_b16 v[94:95], v11 offset:6656
    s_waitcnt lgkmcnt(4)
    v_mfma_f32_32x32x16_bf16 v[64:79], v[84:87], a[4:7], v[64:79]
    ds_read_b64_tr_b16 v[80:81], v11 offset:8192
    ds_read_b64_tr_b16 v[82:83], v11 offset:8704
    s_waitcnt lgkmcnt(4)
    v_mfma_f32_32x32x16_bf16 v[64:79], v[88:91], a[8:11], v[64:79]
    ds_read_b64_tr_b16 v[84:85], v11 offset:10240
    ds_read_b64_tr_b16 v[86:87], v11 offset:10752
    s_add_u32 s96, s15, 4
    s_cmp_ge_u32 s96, 5
    s_cselect_b32 s97, 5, 0
    s_sub_u32 s96, s96, s97
    s_lshl_b32 s97, s96, 13
    s_add_u32 s97, s97, s82
    s_lshl_b32 s96, s96, 16
    s_add_u32 s96, s96, s8
    s_add_u32 m0, s97, 8192
    s_nop 0
    buffer_load_dwordx4 v12, s[40:43], s96 offen lds
    s_waitcnt lgkmcnt(4)
    v_mfma_f32_32x32x16_bf16 v[64:79], v[92:95], a[12:15], v[64:79]
    ds_read_b64_tr_b16 v[88:89], v11 offset:12288
    ds_read_b64_tr_b16 v[90:91], v11 offset:12800
    s_waitcnt lgkmcnt(4)
    v_mfma_f32_32x32x16_bf16 v[64:79], v[80:83], a[16:19], v[64:79]
    ds_read_b64_tr_b16 v[92:93], v11 offset:14336
    ds_read_b64_tr_b16 v[94:95], v11 offset:14848
    s_waitcnt lgkmcnt(4)
    v_mfma_f32_32x32x16_bf16 v[64:79], v[84:87], a[20:23], v[64:79]
    ds_read_b64_tr_b16 v[80:81], v11 offset:16384
    ds_read_b64_tr_b16 v[82:83], v11 offset:16896
    s_add_u32 s96, s15, 0
    s_add_u32 s96, s96, s15
    s_cmp_ge_u32 s96, 6
    s_cselect_b32 s97, 6, 0
    s_sub_u32 s96, s96, s97
    s_cmp_ge_u32 s96, 6
    s_cselect_b32 s97, 6, 0
    s_sub_u32 s96, s96, s97
    s_lshl_b32 s97, s96, 13
    s_add_u32 s97, s97, s82
    s_lshl_b32 s96, s96, 16
    s_add_u32 s96, s96, s8
    s_add_u32 s96, s96, 327680
    s_add_u32 m0, s97, 49152
    s_nop 0
    buffer_load_dwordx4 v12, s[40:43], s96 offen lds
    s_waitcnt lgkmcnt(4)
    v_mfma_f32_32x32x16_bf16 v[64:79], v[88:91], a[24:27], v[64:79]
    ds_read_b64_tr_b16 v[84:85], v11 offset:18432
    ds_read_b64_tr_b16 v[86:87], v11 offset:18944
    s_waitcnt lgkmcnt(4)
    v_mfma_f32_32x32x16_bf16 v[64:79], v[92:95], a[28:31], v[64:79]
    ds_read_b64_tr_b16 v[88:89], v11 offset:20480
    ds_read_b64_tr_b16 v[90:91], v11 offset:20992
    s_waitcnt lgkmcnt(4)
    v_mfma_f32_32x32x16_bf16 v[64:79], v[80:83], a[32:35], v[64:79]
    ds_read_b64_tr_b16 v[92:93], v11 offset:22528
    ds_read_b64_tr_b16 v[94:95], v11 offset:23040
    s_add_u32 s96, s15, 1
    s_add_u32 s96, s96, s15
    s_cmp_ge_u32 s96, 6
    s_cselect_b32 s97, 6, 0
    s_sub_u32 s96, s96, s97
    s_cmp_ge_u32 s96, 6
    s_cselect_b32 s97, 6, 0
    s_sub_u32 s96, s96, s97
    s_lshl_b32 s97, s96, 13
    s_add_u32 s97, s97, s82
    s_lshl_b32 s96, s96, 16
    s_add_u32 s96, s96, s8
    s_add_u32 s96, s96, 327680
    s_add_u32 m0, s97, 49152
    s_nop 0
    buffer_load_dwordx4 v12, s[40:43], s96 offen lds
    s_waitcnt lgkmcnt(4)
    v_mfma_f32_32x32x16_bf16 v[64:79], v[84:87], a[36:39], v[64:79]
    ds_read_b64_tr_b16 v[80:81], v11 offset:24576
    ds_read_b64_tr_b16 v[82:83], v11 offset:25088
    s_waitcnt lgkmcnt(4)
    v_mfma_f32_32x32x16_bf16 v[64:79], v[88:91], a[40:43], v[64:79]
    ds_read_b64_tr_b16 v[84:85], v11 offset:26624
    ds_read_b64_tr_b16 v[86:87], v11 offset:27136
    s_waitcnt lgkmcnt(4)
    v_mfma_f32_32x32x16_bf16 v[64:79], v[92:95], a[44:47], v[64:79]
    ds_read_b64_tr_b16 v[88:89], v11 offset:28672
    ds_read_b64_tr_b16 v[90:91], v11 offset:29184
    s_add_u32 s96, s15, 2
    s_add_u32 s96, s96, s15
    s_cmp_ge_u32 s96, 6
    s_cselect_b32 s97, 6, 0
    s_sub_u32 s96, s96, s97
    s_cmp_ge_u32 s96, 6
    s_cselect_b32 s97, 6, 0
    s_sub_u32 s96, s96, s97
    s_lshl_b32 s97, s96, 13
    s_add_u32 s97, s97, s82
    s_lshl_b32 s96, s96, 16
    s_add_u32 s96, s96, s8
    s_add_u32 s96, s96, 327680
    s_add_u32 m0, s97, 49152
    s_nop 0
    buffer_load_dwordx4 v12, s[40:43], s96 offen lds
    s_waitcnt lgkmcnt(4)
    v_mfma_f32_32x32x16_bf16 v[64:79], v[80:83], a[48:51], v[64:79]
    ds_read_b64_tr_b16 v[92:93], v11 offset:30720
    ds_read_b64_tr_b16 v[94:95], v11 offset:31232
    s_waitcnt lgkmcnt(4)
    v_mfma_f32_32x32x16_bf16 v[64:79], v[84:87], a[52:55], v[64:79]
    s_waitcnt lgkmcnt(2)
    v_mfma_f32_32x32x16_bf16 v[64:79], v[88:91], a[56:59], v[64:79]
    s_add_u32 s96, s15, 3
    s_add_u32 s96, s96, s15
    s_cmp_ge_u32 s96, 6
    s_cselect_b32 s97, 6, 0
    s_sub_u32 s96, s96, s97
    s_cmp_ge_u32 s96, 6
    s_cselect_b32 s97, 6, 0
    s_sub_u32 s96, s96, s97
    s_lshl_b32 s97, s96, 13
    s_add_u32 s97, s97, s82
    s_lshl_b32 s96, s96, 16
    s_add_u32 s96, s96, s8
    s_add_u32 s96, s96, 327680
    s_add_u32 m0, s97, 49152
    s_nop 0
    buffer_load_dwordx4 v12, s[40:43], s96 offen lds
    s_waitcnt lgkmcnt(0)
    v_mfma_f32_32x32x16_bf16 v[64:79], v[92:95], a[60:63], v[64:79]
    ds_read_b64_tr_b16 v[80:81], v11 offset:32768
    ds_read_b64_tr_b16 v[82:83], v11 offset:33280
    ds_read_b64_tr_b16 v[84:85], v11 offset:34816
    ds_read_b64_tr_b16 v[86:87], v11 offset:35328
    ds_read_b64_tr_b16 v[88:89], v11 offset:36864
    ds_read_b64_tr_b16 v[90:91], v11 offset:37376
    s_waitcnt lgkmcnt(4)
    v_mfma_f32_32x32x16_bf16 v[64:79], v[80:83], a[64:67], v[64:79]
    ds_read_b64_tr_b16 v[92:93], v11 offset:38912
    ds_read_b64_tr_b16 v[94:95], v11 offset:39424
    s_waitcnt lgkmcnt(4)
    v_mfma_f32_32x32x16_bf16 v[64:79], v[84:87], a[68:71], v[64:79]
    ds_read_b64_tr_b16 v[80:81], v11 offset:40960
    ds_read_b64_tr_b16 v[82:83], v11 offset:41472
    s_add_u32 s96, s15, 4
    s_add_u32 s96, s96, s15
    s_cmp_ge_u32 s96, 6
    s_cselect_b32 s97, 6, 0
    s_sub_u32 s96, s96, s97
    s_cmp_ge_u32 s96, 6
    s_cselect_b32 s97, 6, 0
    s_sub_u32 s96, s96, s97
    s_lshl_b32 s97, s96, 13
    s_add_u32 s97, s97, s82
    s_lshl_b32 s96, s96, 16
    s_add_u32 s96, s96, s8
    s_add_u32 s96, s96, 327680
    s_add_u32 m0, s97, 49152
    s_nop 0
    buffer_load_dwordx4 v12, s[40:43], s96 offen lds
    s_waitcnt lgkmcnt(4)
    v_mfma_f32_32x32x16_bf16 v[64:79], v[88:91], a[72:75], v[64:79]
    ds_read_b64_tr_b16 v[84:85], v11 offset:43008
    ds_read_b64_tr_b16 v[86:87], v11 offset:43520
    s_waitcnt lgkmcnt(4)
    v_mfma_f32_32x32x16_bf16 v[64:79], v[92:95], a[76:79], v[64:79]
    ds_read_b64_tr_b16 v[88:89], v11 offset:45056
    ds_read_b64_tr_b16 v[90:91], v11 offset:45568
    s_waitcnt lgkmcnt(4)
    v_mfma_f32_32x32x16_bf16 v[64:79], v[80:83], a[80:83], v[64:79]
    ds_read_b64_tr_b16 v[92:93], v11 offset:47104
    ds_read_b64_tr_b16 v[94:95], v11 offset:47616
    s_add_u32 s96, s15, 5
    s_add_u32 s96, s96, s15
    s_cmp_ge_u32 s96, 6
    s_cselect_b32 s97, 6, 0
    s_sub_u32 s96, s96, s97
    s_cmp_ge_u32 s96, 6
    s_cselect_b32 s97, 6, 0
    s_sub_u32 s96, s96, s97
    s_lshl_b32 s97, s96, 13
    s_add_u32 s97, s97, s82
    s_lshl_b32 s96, s96, 16
    s_add_u32 s96, s96, s8
    s_add_u32 s96, s96, 327680
    s_add_u32 m0, s97, 49152
    s_nop 0
    buffer_load_dwordx4 v12, s[40:43], s96 offen lds
    s_waitcnt lgkmcnt(4)
    v_mfma_f32_32x32x16_bf16 v[64:79], v[84:87], a[84:87], v[64:79]
    ds_read_b64_tr_b16 v[80:81], v11 offset:49152
    ds_read_b64_tr_b16 v[82:83], v11 offset:49664
    s_waitcnt lgkmcnt(4)
    v_mfma_f32_32x32x16_bf16 v[64:79], v[88:91], a[88:91], v[64:79]
    ds_read_b64_tr_b16 v[84:85], v11 offset:51200
    ds_read_b64_tr_b16 v[86:87], v11 offset:51712
    s_waitcnt lgkmcnt(4)
    v_mfma_f32_32x32x16_bf16 v[64:79], v[92:95], a[92:95], v[64:79]
    ds_read_b64_tr_b16 v[88:89], v11 offset:53248
    ds_read_b64_tr_b16 v[90:91], v11 offset:53760
    s_waitcnt lgkmcnt(4)
    v_mfma_f32_32x32x16_bf16 v[64:79], v[80:83], a[96:99], v[64:79]
    ds_read_b64_tr_b16 v[92:93], v11 offset:55296
    ds_read_b64_tr_b16 v[94:95], v11 offset:55808
    s_waitcnt lgkmcnt(4)
    v_mfma_f32_32x32x16_bf16 v[64:79], v[84:87], a[100:103], v[64:79]
    ds_read_b64_tr_b16 v[80:81], v11 offset:57344
    ds_read_b64_tr_b16 v[82:83], v11 offset:57856
    s_waitcnt lgkmcnt(4)
    v_mfma_f32_32x32x16_bf16 v[64:79], v[88:91], a[104:107], v[64:79]
    ds_read_b64_tr_b16 v[84:85], v11 offset:59392
    ds_read_b64_tr_b16 v[86:87], v11 offset:59904
    s_waitcnt lgkmcnt(4)
    v_mfma_f32_32x32x16_bf16 v[64:79], v[92:95], a[108:111], v[64:79]
    ds_read_b64_tr_b16 v[88:89], v11 offset:61440
    ds_read_b64_tr_b16 v[90:91], v11 offset:61952
    s_waitcnt lgkmcnt(4)
    v_mfma_f32_32x32x16_bf16 v[64:79], v[80:83], a[112:115], v[64:79]
    ds_read_b64_tr_b16 v[92:93], v11 offset:63488
    ds_read_b64_tr_b16 v[94:95], v11 offset:64000
    s_waitcnt lgkmcnt(4)
    v_mfma_f32_32x32x16_bf16 v[64:79], v[84:87], a[116:119], v[64:79]
    s_waitcnt lgkmcnt(2)
    v_mfma_f32_32x32x16_bf16 v[64:79], v[88:91], a[120:123], v[64:79]
    s_waitcnt lgkmcnt(0)
    v_mfma_f32_32x32x16_bf16 v[64:79], v[92:95], a[124:127], v[64:79]
    s_barrier
    buffer_load_dword v24, v21, s[48:51], 0 offen sc1
    s_nop 9
    v_cvt_pk_bf16_f32 v80, v64, v65
    v_cvt_pk_bf16_f32 v81, v66, v67
    v_cvt_pk_bf16_f32 v82, v68, v69
    v_cvt_pk_bf16_f32 v83, v70, v71
    v_cvt_pk_bf16_f32 v84, v72, v73
    v_cvt_pk_bf16_f32 v85, v74, v75
    v_cvt_pk_bf16_f32 v86, v76, v77
    v_cvt_pk_bf16_f32 v87, v78, v79
    v_mfma_f32_32x32x16_bf16 v[32:47], v[104:107], v[80:83], 0
    s_nop 0
    v_mfma_f32_32x32x16_bf16 v[32:47], v[108:111], v[84:87], v[32:47]
    s_waitcnt vmcnt(11)
    s_mov_b32 s94, 40000
L_gm_67:
    v_readfirstlane_b32 s89, v31
    s_nop 1
    s_and_b32 s90, s89, 31
    s_cselect_b32 s90, 0, s89
    s_cmp_lg_u32 s90, 0
    s_cbranch_scc1 L_gmd_68
    s_sub_u32 s94, s94, 1
    s_cbranch_scc1 L_gmd_68
    s_lshl_b32 s88, s68, 5
    buffer_load_dword v31, off, s[64:67], s88 sc1
    s_waitcnt vmcnt(0)
    s_branch L_gm_67
L_gmd_68:
    s_mul_i32 s90, s95, s95
    s_lshl_b32 s90, s90, 16
    s_lshl_b32 s91, s95, 8
    s_add_u32 s90, s90, s91
    s_add_u32 s90, s90, 1
    s_lshl_b32 s90, s90, 5
    s_cmp_eq_u32 s89, s90
    s_cselect_b32 s77, 1, 0
    s_waitcnt vmcnt(0)
    s_mov_b32 s94, 40000
L_pf_69:
    v_cmp_ne_u32 vcc, s76, v24
    s_nop 1
    s_and_b32 s88, vcc_lo, 0x1f
    s_cbranch_scc0 L_pfd_70
    s_sub_u32 s94, s94, 1
    s_cbranch_scc1 L_pfd_70
    buffer_load_dword v24, v21, s[48:51], 0 offen sc1
    s_waitcnt vmcnt(0)
    s_branch L_pf_69
L_pfd_70:
    s_add_u32 s80, s5, 0
    s_cmp_ge_u32 s80, 5
    s_cselect_b32 s100, 5, 0
    s_sub_u32 s80, s80, s100
    s_lshl_b32 s80, s80, 13
    s_add_u32 s80, s80, s7
    buffer_load_dwordx4 a[0:3], v19, s[48:51], s80 offen offset:0 sc1
    s_add_u32 s80, s5, 1
    s_cmp_ge_u32 s80, 5
    s_cselect_b32 s100, 5, 0
    s_sub_u32 s80, s80, s100
    s_lshl_b32 s80, s80, 13
    s_add_u32 s80, s80, s7
    buffer_load_dwordx4 a[4:7], v19, s[48:51], s80 offen offset:0 sc1
    v_max3_f32 v80, v32, v33, v34
    v_max3_f32 v82, -v32, -v33, -v34
    v_max3_f32 v84, v40, v41, v42
    v_max3_f32 v86, -v40, -v41, -v42
    v_max3_f32 v80, v80, v35, v36
    v_max3_f32 v82, v82, -v35, -v36
    v_max3_f32 v84, v84, v43, v44
    v_max3_f32 v86, v86, -v43, -v44
    v_max3_f32 v80, v80, v37, v38
    v_max3_f32 v82, v82, -v37, -v38
    v_max3_f32 v84, v84, v45, v46
    v_max3_f32 v86, v86, -v45, -v46
    v_max_f32 v80, v80, v39
    v_max_f32_e64 v82, v82, -v39
    v_max_f32 v84, v84, v47
    v_max_f32_e64 v86, v86, -v47
    s_add_u32 s80, s5, 2
    s_cmp_ge_u32 s80, 5
    s_cselect_b32 s100, 5, 0
    s_sub_u32 s80, s80, s100
    s_lshl_b32 s80, s80, 13
    s_add_u32 s80, s80, s7
    buffer_load_dwordx4 a[8:11], v19, s[48:51], s80 offen offset:0 sc1
    v_permlane32_swap_b32 v80, v82
    v_permlane32_swap_b32 v84, v86
    v_max_f32 v80, v80, v82
    v_max_f32 v84, v84, v86
    v_mul_f32 v80, s84, v80
    v_mul_f32 v84, s84, v84
    v_mov_b32 v82, v80
    v_mov_b32 v86, v84
    s_nop 0
    v_permlane32_swap_b32 v80, v82
    v_permlane32_swap_b32 v84, v86
    s_add_u32 s80, s5, 3
    s_cmp_ge_u32 s80, 5
    s_cselect_b32 s100, 5, 0
    s_sub_u32 s80, s80, s100
    s_lshl_b32 s80, s80, 13
    s_add_u32 s80, s80, s7
    buffer_load_dwordx4 a[12:15], v19, s[48:51], s80 offen offset:0 sc1
    v_fma_f32 v48, v32, s84, -v80
    v_fma_f32 v49, v33, s84, -v80
    v_fma_f32 v50, v34, s84, -v80
    v_fma_f32 v51, v35, s84, -v80
    v_fma_f32 v52, v36, s84, -v80
    v_fma_f32 v53, v37, s84, -v80
    v_fma_f32 v54, v38, s84, -v80
    v_fma_f32 v55, v39, s84, -v80
    s_add_u32 s80, s5, 4
    s_cmp_ge_u32 s80, 5
    s_cselect_b32 s100, 5, 0
    s_sub_u32 s80, s80, s100
    s_lshl_b32 s80, s80, 13
    s_add_u32 s80, s80, s7
    buffer_load_dwordx4 a[16:19], v19, s[48:51], s80 offen offset:0 sc1
    v_exp_f32 v48, v48
    v_exp_f32 v49, v49
    v_exp_f32 v50, v50
    v_exp_f32 v51, v51
    v_exp_f32 v52, v52
    v_exp_f32 v53, v53
    v_exp_f32 v54, v54
    v_exp_f32 v55, v55
    s_add_u32 s80, s5, 5
    s_cmp_ge_u32 s80, 10
    s_cselect_b32 s100, 5, 0
    s_sub_u32 s80, s80, s100
    s_lshl_b32 s80, s80, 13
    s_add_u32 s80, s80, s7
    buffer_load_dwordx4 a[20:23], v19, s[48:51], s80 offen offset:0 sc1
    v_cvt_pk_bf16_f32 v112, v48, v49
    v_cvt_pk_bf16_f32 v113, v50, v51
    v_cvt_pk_bf16_f32 v114, v52, v53
    v_cvt_pk_bf16_f32 v115, v54, v55
    v_fma_f32 v56, -v32, s84, -v82
    v_fma_f32 v57, -v33, s84, -v82
    v_fma_f32 v58, -v34, s84, -v82
    v_fma_f32 v59, -v35, s84, -v82
    v_fma_f32 v60, -v36, s84, -v82
    v_fma_f32 v61, -v37, s84, -v82
    v_fma_f32 v62, -v38, s84, -v82
    v_fma_f32 v63, -v39, s84, -v82
    s_add_u32 s80, s5, 6
    s_cmp_ge_u32 s80, 10
    s_cselect_b32 s100, 5, 0
    s_sub_u32 s80, s80, s100
    s_lshl_b32 s80, s80, 13
    s_add_u32 s80, s80, s7
    buffer_load_dwordx4 a[24:27], v19, s[48:51], s80 offen offset:0 sc1
    v_exp_f32 v56, v56
    v_exp_f32 v57, v57
    v_exp_f32 v58, v58
    v_exp_f32 v59, v59
    v_exp_f32 v60, v60
    v_exp_f32 v61, v61
    v_exp_f32 v62, v62
    v_exp_f32 v63, v63
    s_add_u32 s80, s5, 7
    s_cmp_ge_u32 s80, 10
    s_cselect_b32 s100, 5, 0
    s_sub_u32 s80, s80, s100
    s_lshl_b32 s80, s80, 13
    s_add_u32 s80, s80, s7
    buffer_load_dwordx4 a[28:31], v19, s[48:51], s80 offen offset:0 sc1
    v_cvt_pk_bf16_f32 v116, v56, v57
    v_cvt_pk_bf16_f32 v117, v58, v59
    v_cvt_pk_bf16_f32 v118, v60, v61
    v_cvt_pk_bf16_f32 v119, v62, v63
    v_fma_f32 v64, v40, s84, -v84
    v_fma_f32 v65, v41, s84, -v84
    v_fma_f32 v66, v42, s84, -v84
    v_fma_f32 v67, v43, s84, -v84
    v_fma_f32 v68, v44, s84, -v84
    v_fma_f32 v69, v45, s84, -v84
    v_fma_f32 v70, v46, s84, -v84
    v_fma_f32 v71, v47, s84, -v84
    s_add_u32 s80, s5, 8
    s_cmp_ge_u32 s80, 10
    s_cselect_b32 s100, 5, 0
    s_sub_u32 s80, s80, s100
    s_lshl_b32 s80, s80, 13
    s_add_u32 s80, s80, s7
    buffer_load_dwordx4 a[32:35], v19, s[48:51], s80 offen offset:0 sc1
    v_exp_f32 v64, v64
    v_exp_f32 v65, v65
    v_exp_f32 v66, v66
    v_exp_f32 v67, v67
    v_exp_f32 v68, v68
    v_exp_f32 v69, v69
    v_exp_f32 v70, v70
    v_exp_f32 v71, v71
    s_add_u32 s80, s5, 9
    s_cmp_ge_u32 s80, 10
    s_cselect_b32 s100, 5, 0
    s_sub_u32 s80, s80, s100
    s_lshl_b32 s80, s80, 13
    s_add_u32 s80, s80, s7
    buffer_load_dwordx4 a[36:39], v19, s[48:51], s80 offen offset:0 sc1
    v_cvt_pk_bf16_f32 v120, v64, v65
    v_cvt_pk_bf16_f32 v121, v66, v67
    v_cvt_pk_bf16_f32 v122, v68, v69
    v_cvt_pk_bf16_f32 v123, v70, v71
    v_fma_f32 v72, -v40, s84, -v86
    v_fma_f32 v73, -v41, s84, -v86
    v_fma_f32 v74, -v42, s84, -v86
    v_fma_f32 v75, -v43, s84, -v86
    v_fma_f32 v76, -v44, s84, -v86
    v_fma_f32 v77, -v45, s84, -v86
    v_fma_f32 v78, -v46, s84, -v86
    v_fma_f32 v79, -v47, s84, -v86
    s_add_u32 s96, s15, 0
    s_and_b32 s96, s96, 3
    s_lshl_b32 s97, s15, 1
    s_and_b32 s97, s97, 4
    s_xor_b32 s97, s97, 4
    s_add_u32 s96, s96, s97
    s_lshl_b32 s97, s96, 13
    s_add_u32 s97, s97, s82
    s_lshl_b32 s96, s96, 16
    s_add_u32 m0, s97, 98304
    s_nop 0
    buffer_load_dwordx4 v12, s[44:47], s96 offen lds
    v_exp_f32 v72, v72
    v_exp_f32 v73, v73
    v_exp_f32 v74, v74
    v_exp_f32 v75, v75
    v_exp_f32 v76, v76
    v_exp_f32 v77, v77
    v_exp_f32 v78, v78
    v_exp_f32 v79, v79
    s_add_u32 s96, s15, 1
    s_and_b32 s96, s96, 3
    s_lshl_b32 s97, s15, 1
    s_and_b32 s97, s97, 4
    s_xor_b32 s97, s97, 4
    s_add_u32 s96, s96, s97
    s_lshl_b32 s97, s96, 13
    s_add_u32 s97, s97, s82
    s_lshl_b32 s96, s96, 16
    s_add_u32 m0, s97, 98304
    s_nop 0
    buffer_load_dwordx4 v12, s[44:47], s96 offen lds
    v_cvt_pk_bf16_f32 v124, v72, v73
    v_cvt_pk_bf16_f32 v125, v74, v75
    v_cvt_pk_bf16_f32 v126, v76, v77
    v_cvt_pk_bf16_f32 v127, v78, v79
    s_add_u32 s96, s15, 2
    s_and_b32 s96, s96, 3
    s_lshl_b32 s97, s15, 1
    s_and_b32 s97, s97, 4
    s_xor_b32 s97, s97, 4
    s_add_u32 s96, s96, s97
    s_lshl_b32 s97, s96, 13
    s_add_u32 s97, s97, s82
    s_lshl_b32 s96, s96, 16
    s_add_u32 m0, s97, 98304
    s_nop 0
    buffer_load_dwordx4 v12, s[44:47], s96 offen lds
    s_add_u32 s96, s15, 3
    s_and_b32 s96, s96, 3
    s_lshl_b32 s97, s15, 1
    s_and_b32 s97, s97, 4
    s_xor_b32 s97, s97, 4
    s_add_u32 s96, s96, s97
    s_lshl_b32 s97, s96, 13
    s_add_u32 s97, s97, s82
    s_lshl_b32 s96, s96, 16
    s_add_u32 m0, s97, 98304
    s_nop 0
    buffer_load_dwordx4 v12, s[44:47], s96 offen lds
    s_add_u32 s96, s15, 0
    s_and_b32 s96, s96, 3
    s_lshl_b32 s97, s15, 1
    s_and_b32 s97, s97, 4
    s_xor_b32 s97, s97, 0
    s_add_u32 s96, s96, s97
    s_lshl_b32 s97, s96, 13
    s_add_u32 s97, s97, s82
    s_lshl_b32 s96, s96, 16
    s_add_u32 m0, s97, 98304
    s_nop 0
    buffer_load_dwordx4 v12, s[44:47], s96 offen lds
    s_add_u32 s96, s15, 1
    s_and_b32 s96, s96, 3
    s_lshl_b32 s97, s15, 1
    s_and_b32 s97, s97, 4
    s_xor_b32 s97, s97, 0
    s_add_u32 s96, s96, s97
    s_lshl_b32 s97, s96, 13
    s_add_u32 s97, s97, s82
    s_lshl_b32 s96, s96, 16
    s_add_u32 m0, s97, 98304
    s_nop 0
    buffer_load_dwordx4 v12, s[44:47], s96 offen lds
    s_add_u32 s96, s15, 2
    s_and_b32 s96, s96, 3
    s_lshl_b32 s97, s15, 1
    s_and_b32 s97, s97, 4
    s_xor_b32 s97, s97, 0
    s_add_u32 s96, s96, s97
    s_lshl_b32 s97, s96, 13
    s_add_u32 s97, s97, s82
    s_lshl_b32 s96, s96, 16
    s_add_u32 m0, s97, 98304
    s_nop 0
    buffer_load_dwordx4 v12, s[44:47], s96 offen lds
    s_add_u32 s96, s15, 3
    s_and_b32 s96, s96, 3
    s_lshl_b32 s97, s15, 1
    s_and_b32 s97, s97, 4
    s_xor_b32 s97, s97, 0
    s_add_u32 s96, s96, s97
    s_lshl_b32 s97, s96, 13
    s_add_u32 s97, s97, s82
    s_lshl_b32 s96, s96, 16
    s_add_u32 m0, s97, 98304
    s_nop 0
    buffer_load_dwordx4 v12, s[44:47], s96 offen lds
    v_and_b32 v1, 31, v0
    v_lshrrev_b32 v25, 5, v0
    v_lshlrev_b32 v25, 1, v25
    v_and_b32 v26, 7, v0
    v_xor_b32 v25, v25, v26
    v_lshlrev_b32 v25, 4, v25
    v_lshl_add_u32 v1, v1, 8, v25
    s_and_b32 s92, s72, 1
    s_lshl_b32 s92, s92, 15
    s_lshr_b32 s89, s72, 1
    s_lshl_b32 s90, s89, 13
    s_add_u32 s90, s90, s92
    s_add_u32 s90, s90, 8192
    v_add_u32 v1, s90, v1
    v_xor_b32 v2, 16, v1
    v_xor_b32 v3, 64, v1
    v_xor_b32 v4, 0x50, v1
    v_lshrrev_b32 v27, 3, v0
    v_lshlrev_b32 v5, 1, v26
    v_xor_b32 v5, v5, v27
    v_lshlrev_b32 v5, 4, v5
    v_lshl_add_u32 v5, v27, 8, v5
    s_lshl_b32 s90, s89, 11
    s_add_u32 s90, s90, s92
    s_add_u32 s90, s90, 8192
    v_add_u32 v5, s90, v5
    v_xor_b32 v6, 16, v5
    s_lshl_b32 s90, s68, 8
    s_lshl_b32 s91, s15, 6
    s_add_u32 s90, s90, s91
    s_lshr_b32 s91, s92, 10
    s_add_u32 s90, s90, s91
    s_lshl_b32 s85, s90, 3
    s_add_u32 s85, s85, 17891328
    s_lshl_b32 s91, s89, 3
    s_add_u32 s90, s90, s91
    s_lshl_b32 s90, s90, 10
    s_lshl_b32 s91, s3, 7
    s_add_u32 s90, s90, s91
    v_lshlrev_b32 v26, 4, v26
    v_lshl_add_u32 v7, v27, 10, v26
    v_add_u32 v7, s90, v7
    s_lshl_b32 s90, s68, 2
    s_add_u32 s90, s90, s15
    s_lshl_b32 s90, s90, 3
    s_add_u32 s90, s90, s3
    s_lshl_b32 s90, s90, 14
    s_lshr_b32 s91, s92, 3
    s_add_u32 s90, s90, s91
    s_add_u32 s86, s90, 20971520
    s_barrier
    s_add_u32 s96, s5, 0
    s_cmp_ge_u32 s96, 5
    s_cselect_b32 s100, 5, 0
    s_sub_u32 s96, s96, s100
    s_lshl_b32 s96, s96, 13
    v_add_u32 v15, s96, v13
    v_add_u32 v16, s96, v14
    ds_read_b64_tr_b16 v[96:97], v15 offset:8192
    ds_read_b64_tr_b16 v[98:99], v15 offset:8704
    ds_read_b64_tr_b16 v[100:101], v16 offset:8192
    ds_read_b64_tr_b16 v[102:103], v16 offset:8704
    s_add_u32 s96, s5, 1
    s_cmp_ge_u32 s96, 5
    s_cselect_b32 s100, 5, 0
    s_sub_u32 s96, s96, s100
    s_lshl_b32 s96, s96, 13
    v_add_u32 v15, s96, v13
    v_add_u32 v16, s96, v14
    ds_read_b64_tr_b16 v[104:105], v15 offset:8192
    ds_read_b64_tr_b16 v[106:107], v15 offset:8704
    ds_read_b64_tr_b16 v[108:109], v16 offset:8192
    ds_read_b64_tr_b16 v[110:111], v16 offset:8704
    s_add_u32 s96, s5, 2
    s_cmp_ge_u32 s96, 5
    s_cselect_b32 s100, 5, 0
    s_sub_u32 s96, s96, s100
    s_lshl_b32 s96, s96, 13
    v_add_u32 v15, s96, v13
    v_add_u32 v16, s96, v14
    ds_read_b64_tr_b16 a[120:121], v15 offset:8192
    ds_read_b64_tr_b16 a[122:123], v15 offset:8704
    ds_read_b64_tr_b16 a[124:125], v16 offset:8192
    ds_read_b64_tr_b16 a[126:127], v16 offset:8704
    s_waitcnt vmcnt(17) lgkmcnt(8)
    v_mfma_f32_32x32x16_bf16 v[32:47], v[96:99], a[0:3], 0
    v_mfma_f32_32x32x16_bf16 v[48:63], v[100:103], a[0:3], 0
    s_add_u32 s96, s5, 3
    s_cmp_ge_u32 s96, 5
    s_cselect_b32 s100, 5, 0
    s_sub_u32 s96, s96, s100
    s_lshl_b32 s96, s96, 13
    v_add_u32 v15, s96, v13
    v_add_u32 v16, s96, v14
    ds_read_b64_tr_b16 v[96:97], v15 offset:8192
    ds_read_b64_tr_b16 v[98:99], v15 offset:8704
    ds_read_b64_tr_b16 v[100:101], v16 offset:8192
    ds_read_b64_tr_b16 v[102:103], v16 offset:8704
    s_waitcnt vmcnt(16) lgkmcnt(8)
    v_mfma_f32_32x32x16_bf16 v[32:47], v[104:107], a[4:7], v[32:47]
    v_mfma_f32_32x32x16_bf16 v[48:63], v[108:111], a[4:7], v[48:63]
    s_add_u32 s96, s5, 4
    s_cmp_ge_u32 s96, 5
    s_cselect_b32 s100, 5, 0
    s_sub_u32 s96, s96, s100
    s_lshl_b32 s96, s96, 13
    v_add_u32 v15, s96, v13
    v_add_u32 v16, s96, v14
    ds_read_b64_tr_b16 v[104:105], v15 offset:8192
    ds_read_b64_tr_b16 v[106:107], v15 offset:8704
    ds_read_b64_tr_b16 v[108:109], v16 offset:8192
    ds_read_b64_tr_b16 v[110:111], v16 offset:8704
    s_waitcnt vmcnt(15) lgkmcnt(8)
    v_mfma_f32_32x32x16_bf16 v[32:47], a[120:123], a[8:11], v[32:47]
    v_mfma_f32_32x32x16_bf16 v[48:63], a[124:127], a[8:11], v[48:63]
    s_lshl_b32 s88, s13, 3
    s_add_u32 s88, s88, s72
    s_lshl_b32 s4, s88, 10
    s_add_u32 s4, s4, 17956864
    s_lshl_b32 s6, s88, 6
    s_add_u32 s6, s6, 18022400
    v_and_b32 v28, 0x30, v22
    buffer_load_dwordx4 v[8:11], v22, s[48:51], s4 offen sc1
    buffer_load_dwordx4 v[28:31], v28, s[48:51], s6 offen sc1
    s_waitcnt vmcnt(16) lgkmcnt(4)
    v_mfma_f32_32x32x16_bf16 v[32:47], v[96:99], a[12:15], v[32:47]
    v_mfma_f32_32x32x16_bf16 v[48:63], v[100:103], a[12:15], v[48:63]
    s_barrier
    s_add_u32 s96, s5, 5
    s_cmp_ge_u32 s96, 10
    s_cselect_b32 s100, 5, 0
    s_sub_u32 s96, s96, s100
    s_lshl_b32 s96, s96, 13
    v_add_u32 v15, s96, v13
    v_add_u32 v16, s96, v14
    ds_read_b64_tr_b16 a[120:121], v15 offset:8192
    ds_read_b64_tr_b16 a[122:123], v15 offset:8704
    ds_read_b64_tr_b16 a[124:125], v16 offset:8192
    ds_read_b64_tr_b16 a[126:127], v16 offset:8704
    s_add_u32 s96, s5, 6
    s_cmp_ge_u32 s96, 10
    s_cselect_b32 s100, 5, 0
    s_sub_u32 s96, s96, s100
    s_lshl_b32 s96, s96, 13
    v_add_u32 v15, s96, v13
    v_add_u32 v16, s96, v14
    ds_read_b64_tr_b16 v[96:97], v15 offset:8192
    ds_read_b64_tr_b16 v[98:99], v15 offset:8704
    ds_read_b64_tr_b16 v[100:101], v16 offset:8192
    ds_read_b64_tr_b16 v[102:103], v16 offset:8704
    s_waitcnt vmcnt(15) lgkmcnt(8)
    v_mfma_f32_32x32x16_bf16 v[32:47], v[104:107], a[16:19], v[32:47]
    v_mfma_f32_32x32x16_bf16 v[48:63], v[108:111], a[16:19], v[48:63]
    s_waitcnt lgkmcnt(0)
    s_waitcnt vmcnt(0)
    s_mov_b32 s94, 40000
L_h2_71:
    v_cmp_ne_u32 vcc, s76, v10
    v_cmp_ne_u32 s[98:99], s76, v30
    s_nop 1
    s_or_b64 vcc, vcc, s[98:99]
    s_cbranch_vccz L_h2d_72
    s_sub_u32 s94, s94, 1
    s_cbranch_scc1 L_h2d_72
    v_and_b32 v28, 0x30, v22
    buffer_load_dwordx4 v[8:11], v22, s[48:51], s4 offen sc1
    buffer_load_dwordx4 v[28:31], v28, s[48:51], s6 offen sc1
    s_waitcnt vmcnt(0)
    s_branch L_h2_71
L_h2d_72:
    s_add_u32 s88, s82, 0
    v_and_b32 v26, 15, v0
    v_lshrrev_b32 v27, 4, v0
    v_lshlrev_b32 v27, 3, v27
    v_lshl_add_u32 v26, v26, 5, v27
    v_add_u32 v26, s88, v26
    v_lshlrev_b32 v27, 3, v0
    v_add_u32 v27, s88, v27
    ds_write_b64 v26, v[8:9]
    v_cmp_gt_u32 vcc, 4, v0
    v_mov_b32 v25, 0x3f803f80
    s_nop 0
    v_cndmask_b32 v28, v25, v28, vcc
    v_cndmask_b32 v29, v25, v29, vcc
    s_mov_b64 exec, 0xff
    ds_write_b64 v27, v[28:29] offset:512
    s_mov_b64 exec, -1
    v_and_b32 v27, 3, v0
    v_bfe_u32 v25, v0, 2, 1
    v_bfe_u32 v26, v0, 3, 1
    v_lshl_add_u32 v27, v25, 3, v27
    v_lshl_add_u32 v27, v26, 2, v27
    v_add_u32 v26, 16, v26
    v_and_b32 v25, 16, v0
    v_cmp_eq_u32 vcc, 0, v25
    v_lshrrev_b32 v25, 5, v0
    v_lshlrev_b32 v25, 4, v25
    v_cndmask_b32 v27, v26, v27, vcc
    v_lshl_add_u32 v27, v27, 5, v25
    s_lshl_b32 s88, s74, 12
    s_add_u32 s88, s88, 0
    v_add_u32 v27, s88, v27
    s_waitcnt lgkmcnt(0)
    s_barrier
    ds_read_b128 v[8:11], v27 offset:0
    ds_read_b128 v[28:31], v27 offset:1024
    ds_read_b128 a[112:115], v27 offset:2048
    ds_read_b128 a[116:119], v27 offset:3072
    s_lshl_b32 s88, s13, 13
    s_add_u32 s88, s88, 180224
    s_add_u32 s89, s88, 2048
    s_mov_b32 s90, 0x358637bd
    s_waitcnt lgkmcnt(2)
    v_mfma_f32_32x32x16_bf16 v[80:95], v[28:31], v[116:119], 0
    v_mfma_f32_32x32x16_bf16 v[64:79], v[8:11], v[112:115], 0
    s_nop 10
    v_rcp_f32 v25, v92
    v_fma_f32 v26, v76, s90, v72
    v_mul_f32 v25, v76, v25
    v_fmac_f32 v26, v25, v88
    v_rcp_f32 v26, v26
    v_fmac_f32 v64, v25, v80
    v_fmac_f32 v65, v25, v81
    v_fmac_f32 v66, v25, v82
    v_fmac_f32 v67, v25, v83
    v_fmac_f32 v68, v25, v84
    v_fmac_f32 v69, v25, v85
    v_fmac_f32 v70, v25, v86
    v_fmac_f32 v71, v25, v87
    s_waitcnt lgkmcnt(0)
    v_mfma_f32_32x32x16_bf16 v[80:95], a[116:119], v[124:127], 0
    v_mul_f32 v64, v26, v64
    v_mul_f32 v65, v26, v65
    v_mul_f32 v66, v26, v66
    v_mul_f32 v67, v26, v67
    v_mul_f32 v68, v26, v68
    v_mul_f32 v69, v26, v69
    v_mul_f32 v70, v26, v70
    v_mul_f32 v71, v26, v71
    v_cvt_pk_bf16_f32 v112, v64, v65
    v_cvt_pk_bf16_f32 v113, v66, v67
    v_cvt_pk_bf16_f32 v114, v68, v69
    v_cvt_pk_bf16_f32 v115, v70, v71
    v_mfma_f32_32x32x16_bf16 v[64:79], a[112:115], v[120:123], 0
    v_rcp_f32 v25, v92
    s_nop 10
    v_fma_f32 v26, v76, s90, v72
    v_mul_f32 v25, v76, v25
    v_fmac_f32 v26, v25, v88
    v_rcp_f32 v26, v26
    v_fmac_f32 v64, v25, v80
    v_fmac_f32 v65, v25, v81
    v_fmac_f32 v66, v25, v82
    v_fmac_f32 v67, v25, v83
    v_fmac_f32 v68, v25, v84
    v_fmac_f32 v69, v25, v85
    v_fmac_f32 v70, v25, v86
    v_fmac_f32 v71, v25, v87
    v_mul_f32 v64, v26, v64
    v_mul_f32 v65, v26, v65
    v_mul_f32 v66, v26, v66
    v_mul_f32 v67, v26, v67
    v_mul_f32 v68, v26, v68
    v_mul_f32 v69, v26, v69
    v_mul_f32 v70, v26, v70
    v_mul_f32 v71, v26, v71
    v_cvt_pk_bf16_f32 v120, v64, v65
    v_cvt_pk_bf16_f32 v121, v66, v67
    v_cvt_pk_bf16_f32 v122, v68, v69
    v_cvt_pk_bf16_f32 v123, v70, v71
    s_cmp_eq_u32 s77, 1
    s_cbranch_scc0 L_sl_73
    buffer_store_dwordx4 v[112:115], v20, s[48:51], s88 offen sc1
    buffer_store_dwordx4 v[120:123], v20, s[48:51], s89 offen sc1
    s_branch L_sd_74
L_sl_73:
    buffer_store_dwordx4 v[112:115], v20, s[48:51], s88 offen sc1
    buffer_store_dwordx4 v[120:123], v20, s[48:51], s89 offen sc1
L_sd_74:
    s_add_u32 s96, s5, 7
    s_cmp_ge_u32 s96, 10
    s_cselect_b32 s100, 5, 0
    s_sub_u32 s96, s96, s100
    s_lshl_b32 s96, s96, 13
    v_add_u32 v15, s96, v13
    v_add_u32 v16, s96, v14
    ds_read_b64_tr_b16 v[104:105], v15 offset:8192
    ds_read_b64_tr_b16 v[106:107], v15 offset:8704
    ds_read_b64_tr_b16 v[108:109], v16 offset:8192
    ds_read_b64_tr_b16 v[110:111], v16 offset:8704
    v_mfma_f32_32x32x16_bf16 v[32:47], a[120:123], a[20:23], v[32:47]
    v_mfma_f32_32x32x16_bf16 v[48:63], a[124:127], a[20:23], v[48:63]
    buffer_load_dword v24, v21, s[48:51], 0 offen sc1
    s_add_u32 s96, s5, 8
    s_cmp_ge_u32 s96, 10
    s_cselect_b32 s100, 5, 0
    s_sub_u32 s96, s96, s100
    s_lshl_b32 s96, s96, 13
    v_add_u32 v15, s96, v13
    v_add_u32 v16, s96, v14
    ds_read_b64_tr_b16 a[120:121], v15 offset:8192
    ds_read_b64_tr_b16 a[122:123], v15 offset:8704
    ds_read_b64_tr_b16 a[124:125], v16 offset:8192
    ds_read_b64_tr_b16 a[126:127], v16 offset:8704
    v_mfma_f32_32x32x16_bf16 v[32:47], v[96:99], a[24:27], v[32:47]
    v_mfma_f32_32x32x16_bf16 v[48:63], v[100:103], a[24:27], v[48:63]
    s_waitcnt vmcnt(1)
    s_and_b32 s89, s69, 1
    s_lshl_b32 s88, s68, 1
    s_add_u32 s88, s88, s89
    s_lshl_b32 s88, s88, 2
    s_add_u32 s88, s88, s73
    s_lshl_b32 s88, s88, 1
    s_add_u32 s88, s88, s74
    s_lshl_b32 s88, s88, 4
    s_add_u32 s88, s88, s13
    s_lshl_b32 s88, s88, 2
    s_add_u32 s88, s88, 18104320
    v_mov_b32 v25, s76
    s_mov_b64 exec, 1
    s_cmp_eq_u32 s77, 1
    s_cbranch_scc0 L_sl_75
    buffer_store_dword v25, off, s[48:51], s88
    s_branch L_sd_76
L_sl_75:
    buffer_store_dword v25, off, s[48:51], s88 sc1
L_sd_76:
    s_mov_b64 exec, -1
    s_add_u32 s96, s5, 9
    s_cmp_ge_u32 s96, 10
    s_cselect_b32 s100, 5, 0
    s_sub_u32 s96, s96, s100
    s_lshl_b32 s96, s96, 13
    v_add_u32 v15, s96, v13
    v_add_u32 v16, s96, v14
    ds_read_b64_tr_b16 v[96:97], v15 offset:8192
    ds_read_b64_tr_b16 v[98:99], v15 offset:8704
    ds_read_b64_tr_b16 v[100:101], v16 offset:8192
    ds_read_b64_tr_b16 v[102:103], v16 offset:8704
    s_waitcnt lgkmcnt(8)
    v_mfma_f32_32x32x16_bf16 v[32:47], v[104:107], a[28:31], v[32:47]
    v_mfma_f32_32x32x16_bf16 v[48:63], v[108:111], a[28:31], v[48:63]
    s_waitcnt vmcnt(1)
    s_mov_b32 s94, 40000
L_pf_77:
    v_cmp_ne_u32 vcc, s76, v24
    s_nop 1
    s_and_b32 s88, vcc_lo, 0x1000
    s_cbranch_scc0 L_pfd_78
    s_sub_u32 s94, s94, 1
    s_cbranch_scc1 L_pfd_78
    buffer_load_dword v24, v21, s[48:51], 0 offen sc1
    s_waitcnt vmcnt(0)
    s_branch L_pf_77
L_pfd_78:
    s_mov_b32 s80, 10
    s_lshl_b32 s80, s80, 13
    s_add_u32 s80, s80, s7
    s_and_b32 s100, s16, s74
    s_cselect_b32 s80, 0x40000000, s80
    buffer_load_dwordx4 a[40:43], v19, s[48:51], s80 offen offset:0 sc1
    s_mov_b32 s96, 10
    s_lshl_b32 s96, s96, 13
    v_add_u32 v15, s96, v13
    v_add_u32 v16, s96, v14
    ds_read_b64_tr_b16 v[104:105], v15 offset:8192
    ds_read_b64_tr_b16 v[106:107], v15 offset:8704
    ds_read_b64_tr_b16 v[108:109], v16 offset:8192
    ds_read_b64_tr_b16 v[110:111], v16 offset:8704
    s_waitcnt lgkmcnt(8)
    v_mfma_f32_32x32x16_bf16 v[32:47], a[120:123], a[32:35], v[32:47]
    v_mfma_f32_32x32x16_bf16 v[48:63], a[124:127], a[32:35], v[48:63]
    s_waitcnt lgkmcnt(4)
    v_mfma_f32_32x32x16_bf16 v[32:47], v[96:99], a[36:39], v[32:47]
    v_mfma_f32_32x32x16_bf16 v[48:63], v[100:103], a[36:39], v[48:63]
    s_waitcnt vmcnt(0) lgkmcnt(0)
    v_mfma_f32_32x32x16_bf16 v[32:47], v[104:107], a[40:43], v[32:47]
    v_mfma_f32_32x32x16_bf16 v[48:63], v[108:111], a[40:43], v[48:63]
    s_mov_b32 s56, s20
    s_mov_b32 s57, s21
    s_mov_b32 s58, 2097152
    s_mov_b32 s59, 0x20000
    v_and_b32 v26, 31, v0
    v_lshlrev_b32 v26, 3, v26
    v_and_b32 v28, 0x38, v0
    s_lshr_b32 s89, s72, 1
    s_lshl_b32 s89, s89, 6
    s_add_u32 s89, s89, s85
    buffer_load_dwordx2 v[26:27], v26, s[48:51], s85 offen sc1
    buffer_load_dwordx2 v[28:29], v28, s[48:51], s89 offen sc1
    buffer_load_dword v24, v21, s[48:51], 0 offen sc1
    s_barrier
    ds_read_b64_tr_b16 v[96:97], v17 offset:0
    ds_read_b64_tr_b16 v[98:99], v17 offset:512
    ds_read_b64_tr_b16 v[100:101], v18 offset:0
    ds_read_b64_tr_b16 v[102:103], v18 offset:512
    s_waitcnt vmcnt(1)
    s_mov_b32 s94, 40000
L_sp_79:
    v_cmp_ne_u32 vcc, s76, v27
    v_cmp_ne_u32 s[98:99], s76, v29
    s_nop 1
    s_or_b64 vcc, vcc, s[98:99]
    s_cbranch_vccz L_spd_80
    s_sub_u32 s94, s94, 1
    s_cbranch_scc1 L_spd_80
    v_and_b32 v26, 31, v0
    v_lshlrev_b32 v26, 3, v26
    v_and_b32 v28, 0x38, v0
    s_lshr_b32 s89, s72, 1
    s_lshl_b32 s89, s89, 6
    s_add_u32 s89, s89, s85
    buffer_load_dwordx2 v[26:27], v26, s[48:51], s85 offen sc1
    buffer_load_dwordx2 v[28:29], v28, s[48:51], s89 offen sc1
    s_waitcnt vmcnt(0)
    s_branch L_sp_79
L_spd_80:
    s_waitcnt vmcnt(0)
    s_mov_b32 s94, 40000
L_pf_81:
    v_cmp_ne_u32 vcc, s76, v24
    s_nop 1
    s_and_b32 s88, vcc_hi, 0xff
    s_cbranch_scc0 L_pfd_82
    s_sub_u32 s94, s94, 1
    s_cbranch_scc1 L_pfd_82
    buffer_load_dword v24, v21, s[48:51], 0 offen sc1
    s_waitcnt vmcnt(0)
    s_branch L_pf_81
L_pfd_82:
    s_lshl_b32 s93, s16, 21
    s_add_u32 s93, s93, 180224
    s_add_u32 s88, s93, 0
    buffer_load_dwordx4 a[0:3], v19, s[48:51], s88 offen sc1
    v_sub_f32 v27, 1.0, v26
    v_sub_f32 v28, 1.0, v28
    v_mul_f32 v32, v27, v32
    v_mul_f32 v33, v27, v33
    v_mul_f32 v34, v27, v34
    v_mul_f32 v35, v27, v35
    v_mul_f32 v36, v27, v36
    s_add_u32 s88, s93, 8192
    buffer_load_dwordx4 a[4:7], v19, s[48:51], s88 offen sc1
    v_mul_f32 v37, v27, v37
    v_mul_f32 v38, v27, v38
    v_mul_f32 v39, v27, v39
    v_mul_f32 v40, v27, v40
    v_mul_f32 v41, v27, v41
    s_add_u32 s88, s93, 16384
    buffer_load_dwordx4 a[8:11], v19, s[48:51], s88 offen sc1
    v_mul_f32 v42, v27, v42
    v_mul_f32 v43, v27, v43
    v_mul_f32 v44, v27, v44
    v_mul_f32 v45, v27, v45
    v_mul_f32 v46, v27, v46
    v_mul_f32 v47, v27, v47
    s_add_u32 s88, s93, 24576
    buffer_load_dwordx4 a[12:15], v19, s[48:51], s88 offen sc1
    v_mul_f32 v48, v27, v48
    v_mul_f32 v49, v27, v49
    v_mul_f32 v50, v27, v50
    v_mul_f32 v51, v27, v51
    v_mul_f32 v52, v27, v52
    s_add_u32 s88, s93, 32768
    buffer_load_dwordx4 a[16:19], v19, s[48:51], s88 offen sc1
    v_mul_f32 v53, v27, v53
    v_mul_f32 v54, v27, v54
    v_mul_f32 v55, v27, v55
    v_mul_f32 v56, v27, v56
    v_mul_f32 v57, v27, v57
    s_add_u32 s88, s93, 40960
    buffer_load_dwordx4 a[20:23], v19, s[48:51], s88 offen sc1
    v_mul_f32 v58, v27, v58
    v_mul_f32 v59, v27, v59
    v_mul_f32 v60, v27, v60
    v_mul_f32 v61, v27, v61
    v_mul_f32 v62, v27, v62
    v_mul_f32 v63, v27, v63
    ds_read_b64_tr_b16 v[104:105], v17 offset:8192
    ds_read_b64_tr_b16 v[106:107], v17 offset:8704
    ds_read_b64_tr_b16 v[108:109], v18 offset:8192
    ds_read_b64_tr_b16 v[110:111], v18 offset:8704
    s_add_u32 s88, s93, 49152
    buffer_load_dwordx4 a[24:27], v19, s[48:51], s88 offen sc1
    buffer_load_dword v24, v21, s[48:51], 0 offen sc1
    s_waitcnt vmcnt(7) lgkmcnt(4)
    v_mfma_f32_32x32x16_bf16 v[64:79], v[96:99], a[0:3], 0
    v_mfma_f32_32x32x16_bf16 v[80:95], v[100:103], a[0:3], 0
    ds_read_b64_tr_b16 v[96:97], v17 offset:16384
    ds_read_b64_tr_b16 v[98:99], v17 offset:16896
    ds_read_b64_tr_b16 v[100:101], v18 offset:16384
    ds_read_b64_tr_b16 v[102:103], v18 offset:16896
    s_add_u32 s88, s93, 57344
    buffer_load_dwordx4 a[28:31], v19, s[48:51], s88 offen sc1
    s_waitcnt vmcnt(7) lgkmcnt(4)
    v_mfma_f32_32x32x16_bf16 v[64:79], v[104:107], a[4:7], v[64:79]
    v_mfma_f32_32x32x16_bf16 v[80:95], v[108:111], a[4:7], v[80:95]
    ds_read_b64_tr_b16 v[104:105], v17 offset:24576
    ds_read_b64_tr_b16 v[106:107], v17 offset:25088
    ds_read_b64_tr_b16 v[108:109], v18 offset:24576
    ds_read_b64_tr_b16 v[110:111], v18 offset:25088
    s_waitcnt vmcnt(6) lgkmcnt(4)
    v_mfma_f32_32x32x16_bf16 v[64:79], v[96:99], a[8:11], v[64:79]
    v_mfma_f32_32x32x16_bf16 v[80:95], v[100:103], a[8:11], v[80:95]
    ds_read_b64_tr_b16 v[96:97], v17 offset:32768
    ds_read_b64_tr_b16 v[98:99], v17 offset:33280
    ds_read_b64_tr_b16 v[100:101], v18 offset:32768
    ds_read_b64_tr_b16 v[102:103], v18 offset:33280
    s_waitcnt vmcnt(5) lgkmcnt(4)
    v_mfma_f32_32x32x16_bf16 v[64:79], v[104:107], a[12:15], v[64:79]
    v_mfma_f32_32x32x16_bf16 v[80:95], v[108:111], a[12:15], v[80:95]
    ds_read_b64_tr_b16 v[104:105], v17 offset:40960
    ds_read_b64_tr_b16 v[106:107], v17 offset:41472
    ds_read_b64_tr_b16 v[108:109], v18 offset:40960
    ds_read_b64_tr_b16 v[110:111], v18 offset:41472
    s_waitcnt vmcnt(1)
    s_mov_b32 s94, 40000
L_pf_83:
    v_cmp_ne_u32 vcc, s76, v24
    s_nop 1
    s_and_b32 s88, vcc_hi, 0x30000
    s_cbranch_scc0 L_pfd_84
    s_sub_u32 s94, s94, 1
    s_cbranch_scc1 L_pfd_84
    buffer_load_dword v24, v21, s[48:51], 0 offen sc1
    s_waitcnt vmcnt(0)
    s_branch L_pf_83
L_pfd_84:
    s_xor_b32 s90, s86, 524288
    s_lshr_b32 s91, s72, 1
    s_lshl_b32 s91, s91, 7
    s_add_u32 s90, s90, s91
    v_bfe_u32 v8, v0, 1, 2
    v_and_b32 v9, 1, v0
    v_lshlrev_b32 v8, 10, v8
    v_lshl_add_u32 v8, v9, 9, v8
    v_lshrrev_b32 v9, 3, v0
    v_lshl_add_u32 v8, v9, 4, v8
    buffer_load_dwordx4 v[120:123], v8, s[48:51], s90 offen sc1
    s_waitcnt lgkmcnt(4)
    v_mfma_f32_32x32x16_bf16 v[64:79], v[96:99], a[16:19], v[64:79]
    v_mfma_f32_32x32x16_bf16 v[80:95], v[100:103], a[16:19], v[80:95]
    ds_read_b64_tr_b16 v[96:97], v17 offset:49152
    ds_read_b64_tr_b16 v[98:99], v17 offset:49664
    ds_read_b64_tr_b16 v[100:101], v18 offset:49152
    ds_read_b64_tr_b16 v[102:103], v18 offset:49664
    s_waitcnt lgkmcnt(4)
    v_mfma_f32_32x32x16_bf16 v[64:79], v[104:107], a[20:23], v[64:79]
    v_mfma_f32_32x32x16_bf16 v[80:95], v[108:111], a[20:23], v[80:95]
    ds_read_b64_tr_b16 v[104:105], v17 offset:57344
    ds_read_b64_tr_b16 v[106:107], v17 offset:57856
    ds_read_b64_tr_b16 v[108:109], v18 offset:57344
    ds_read_b64_tr_b16 v[110:111], v18 offset:57856
    s_waitcnt lgkmcnt(4)
    v_mfma_f32_32x32x16_bf16 v[64:79], v[96:99], a[24:27], v[64:79]
    v_mfma_f32_32x32x16_bf16 v[80:95], v[100:103], a[24:27], v[80:95]
    s_waitcnt vmcnt(1) lgkmcnt(0)
    v_mfma_f32_32x32x16_bf16 v[64:79], v[104:107], a[28:31], v[64:79]
    v_mfma_f32_32x32x16_bf16 v[80:95], v[108:111], a[28:31], v[80:95]
    s_nop 10
    v_pk_fma_f32 v[32:33], v[64:65], v[26:27], v[32:33] op_sel_hi:[1,0,1]
    v_pk_fma_f32 v[34:35], v[66:67], v[26:27], v[34:35] op_sel_hi:[1,0,1]
    ds_write_b128 v1, v[32:35] offset:0
    v_pk_fma_f32 v[36:37], v[68:69], v[26:27], v[36:37] op_sel_hi:[1,0,1]
    v_pk_fma_f32 v[38:39], v[70:71], v[26:27], v[38:39] op_sel_hi:[1,0,1]
    ds_write_b128 v2, v[36:39] offset:0
    v_pk_fma_f32 v[40:41], v[72:73], v[26:27], v[40:41] op_sel_hi:[1,0,1]
    v_pk_fma_f32 v[42:43], v[74:75], v[26:27], v[42:43] op_sel_hi:[1,0,1]
    ds_write_b128 v3, v[40:43] offset:0
    v_pk_fma_f32 v[44:45], v[76:77], v[26:27], v[44:45] op_sel_hi:[1,0,1]
    v_pk_fma_f32 v[46:47], v[78:79], v[26:27], v[46:47] op_sel_hi:[1,0,1]
    ds_write_b128 v4, v[44:47] offset:0
    v_pk_fma_f32 v[48:49], v[80:81], v[26:27], v[48:49] op_sel_hi:[1,0,1]
    v_pk_fma_f32 v[50:51], v[82:83], v[26:27], v[50:51] op_sel_hi:[1,0,1]
    ds_write_b128 v1, v[48:51] offset:128
    v_pk_fma_f32 v[52:53], v[84:85], v[26:27], v[52:53] op_sel_hi:[1,0,1]
    v_pk_fma_f32 v[54:55], v[86:87], v[26:27], v[54:55] op_sel_hi:[1,0,1]
    ds_write_b128 v2, v[52:55] offset:128
    v_pk_fma_f32 v[56:57], v[88:89], v[26:27], v[56:57] op_sel_hi:[1,0,1]
    v_pk_fma_f32 v[58:59], v[90:91], v[26:27], v[58:59] op_sel_hi:[1,0,1]
    ds_write_b128 v3, v[56:59] offset:128
    v_pk_fma_f32 v[60:61], v[92:93], v[26:27], v[60:61] op_sel_hi:[1,0,1]
    v_pk_fma_f32 v[62:63], v[94:95], v[26:27], v[62:63] op_sel_hi:[1,0,1]
    ds_write_b128 v4, v[60:63] offset:128
    s_waitcnt vmcnt(0)
    v_lshlrev_b32 v112, 16, v120
    v_and_b32 v113, 0xffff0000, v120
    v_lshlrev_b32 v114, 16, v121
    v_and_b32 v115, 0xffff0000, v121
    v_lshlrev_b32 v116, 16, v122
    v_and_b32 v117, 0xffff0000, v122
    v_lshlrev_b32 v118, 16, v123
    v_and_b32 v119, 0xffff0000, v123
    s_waitcnt lgkmcnt(0)
    s_barrier
    ds_read_b128 v[64:67], v5 offset:0
    ds_read_b128 v[68:71], v6 offset:0
    ds_read_b128 v[72:75], v5 offset:8192
    ds_read_b128 v[76:79], v6 offset:8192
    ds_read_b128 v[80:83], v5 offset:16384
    ds_read_b128 v[84:87], v6 offset:16384
    ds_read_b128 v[88:91], v5 offset:24576
    ds_read_b128 v[92:95], v6 offset:24576
    s_waitcnt lgkmcnt(4)
    v_pk_add_f32 v[64:65], v[64:65], v[72:73]
    v_pk_add_f32 v[66:67], v[66:67], v[74:75]
    v_pk_add_f32 v[68:69], v[68:69], v[76:77]
    v_pk_add_f32 v[70:71], v[70:71], v[78:79]
    s_waitcnt lgkmcnt(0)
    v_pk_add_f32 v[80:81], v[80:81], v[88:89]
    v_pk_add_f32 v[82:83], v[82:83], v[90:91]
    v_pk_add_f32 v[84:85], v[84:85], v[92:93]
    v_pk_add_f32 v[86:87], v[86:87], v[94:95]
    v_pk_add_f32 v[64:65], v[64:65], v[80:81]
    v_pk_add_f32 v[66:67], v[66:67], v[82:83]
    v_pk_add_f32 v[68:69], v[68:69], v[84:85]
    v_pk_add_f32 v[70:71], v[70:71], v[86:87]
    v_pk_fma_f32 v[64:65], v[112:113], v[28:29], v[64:65] op_sel_hi:[1,0,1]
    v_pk_fma_f32 v[66:67], v[114:115], v[28:29], v[66:67] op_sel_hi:[1,0,1]
    v_pk_fma_f32 v[68:69], v[116:117], v[28:29], v[68:69] op_sel_hi:[1,0,1]
    v_pk_fma_f32 v[70:71], v[118:119], v[28:29], v[70:71] op_sel_hi:[1,0,1]
    v_cvt_pk_bf16_f32 v72, v64, v65
    v_cvt_pk_bf16_f32 v73, v66, v67
    v_cvt_pk_bf16_f32 v74, v68, v69
    v_cvt_pk_bf16_f32 v75, v70, v71
    buffer_store_dwordx4 v[72:75], v7, s[56:59], 0 offen nt
    s_endpgm
L_end:
    s_endpgm
.section .rodata,"a"
.p2align 6
.amdhsa_kernel gated_mix__linear_kernel_hedgehog__dense_activation_relu__prompt_kernel
  .amdhsa_next_free_vgpr 256
  .amdhsa_next_free_sgpr 102
  .amdhsa_accum_offset 128
  .amdhsa_group_segment_fixed_size 0
  .amdhsa_kernarg_size 88
  .amdhsa_user_sgpr_count 2
  .amdhsa_user_sgpr_kernarg_segment_ptr 1
  .amdhsa_system_sgpr_workgroup_id_x 1
.end_amdhsa_kernel
```
